```python
import torch

def _softmax(x, axis=-1):
    return torch.softmax(x, dim=axis)
def _gelu(x):
    return torch.nn.functional.gelu(x, approximate="tanh")
def _silu(x):
    return torch.nn.functional.silu(x)
def _sigmoid(x):
    return torch.sigmoid(x)
def _layernorm(x, axis=-1, eps=1e-5):
    m = x.mean(dim=axis, keepdim=True)
    v = x.var(dim=axis, keepdim=True, unbiased=False)
    return (x - m) / torch.sqrt(v + eps)
def _scatter_add(tgt, idx, src, axis=0):
    return tgt.clone().index_add_(axis, idx, src)
def _segment_sum(src, seg, n):
    out = torch.zeros((n,) + src.shape[1:], dtype=src.dtype)
    return out.index_add_(0, seg, src)
def _pad(x, pw):
    flat = tuple(v for pair in reversed(pw) for v in pair)
    return torch.nn.functional.pad(x, flat)

kernel_name = 'standalone__cheap_equivariant_egnn__graph'

def setup_inputs():

    _w = (lambda a: (lambda t: t.to(torch.bfloat16) if t.is_floating_point() else t)(torch.as_tensor(a)))
    N, deg, D, De = 12500, 64, 64, max(16, 1)
    E = N * deg
    return {
        "h": _w((lambda *s: torch.randn(*s, dtype=torch.bfloat16) * 0.1)(N, D)),
        "pos": _w((lambda *s: torch.randn(*s, dtype=torch.bfloat16) * 0.8)(N, 3)),
        "e_attr": _w((lambda *s: torch.randn(*s, dtype=torch.bfloat16) * 0.8)(E, De)),
        "src": _w((lambda lo, hi, *s: torch.randint(lo, hi, s))(0, N, E).to(torch.int64)),
        "dst": _w((lambda lo, hi, *s: torch.randint(lo, hi, s))(0, N, E).to(torch.int64)),
        "w_e": _w(0.1 * (lambda *s: torch.randn(*s, dtype=torch.bfloat16) * 0.8)(2 * D + 1 + De, D)),
        "w_x": _w(0.1 * (lambda *s: torch.randn(*s, dtype=torch.bfloat16) * 0.1)(D, 1)),
        "w_h": _w(0.1 * (lambda *s: torch.randn(*s, dtype=torch.bfloat16) * 0.1)(2 * D, D)),
    }

def reference(h, pos, e_attr, src, dst, w_e, w_x, w_h):
    N, D = h.shape[0], h.shape[1]
    diff = pos[dst] - pos[src]
    dist2 = torch.sum(diff * diff, axis=-1, keepdims=True)
    e_in = torch.concatenate([h[dst], h[src], dist2, e_attr], axis=-1)
    m_ij = _silu(e_in @ w_e)
    coord_scale = m_ij @ w_x
    pos_new = pos + _segment_sum(diff * coord_scale, dst, N)
    m_i = _segment_sum(m_ij, dst, N)
    h_new = h + _silu(torch.concatenate([h, m_i], axis=-1) @ w_h)
    return h_new, pos_new
```

```asm
; @launch kernel=standalone__cheap_equivariant_egnn__graph_kernel grid=(256,1,1) block=(512,1,1) lds=163336
.amdgcn_target "amdgcn-amd-amdhsa--gfx950"
.text
.globl standalone__cheap_equivariant_egnn__graph_kernel
.p2align 8
.type standalone__cheap_equivariant_egnn__graph_kernel,@function
standalone__cheap_equivariant_egnn__graph_kernel:
    s_cmpk_ge_u32 s2, 256
    s_cbranch_scc1 L2_end
    s_load_dwordx2 s[60:61], s[0:1], 32
    s_load_dwordx2 s[10:11], s[0:1], 80
    s_getpc_b64 s[4:5]
L_pc:
    s_lshr_b32 s91, s2, 3
    v_lshl_add_u32 v215, v0, 5, s91
    v_lshlrev_b32 v215, 7, v215
    v_cmpx_gt_u32 vcc, L_code_end-L_pc, v215
    s_cbranch_execz L_nopc
    global_load_dword v239, v215, s[4:5]
L_nopc:
    s_mov_b64 exec, -1
    s_load_dwordx2 s[56:57], s[0:1], 24
    s_load_dwordx2 s[16:17], s[0:1], 0
    s_load_dwordx2 s[64:65], s[0:1], 40
    s_load_dwordx2 s[20:21], s[0:1], 8
    s_load_dwordx2 s[68:69], s[0:1], 72
    v_lshrrev_b32 v215, 6, v0
    v_lshlrev_b32 v140, 4, v0
    v_readfirstlane_b32 s88, v215
    v_mul_u32_u24 v141, 12, v0
    v_add_u32 v141, 7168, v141
    v_and_b32 v1, 63, v0
    v_lshlrev_b32 v158, 4, v1
    s_mul_i32 s80, s2, 12544
    s_lshl_b32 s85, s2, 10
    s_mov_b32 s62, 0x30d400
    s_mov_b32 s63, 0x20000
    s_mov_b32 s58, 0x30d400
    s_mov_b32 s59, 0x20000
    s_mov_b32 s54, 0x40000
    s_mov_b32 s55, 0x20000
    v_mov_b32 v184, 0
    v_mov_b32 v185, 0
    v_mov_b32 v186, 0
    v_mov_b32 v187, 0
    s_cmp_eq_u32 s88, 7
    s_waitcnt lgkmcnt(0)
    s_cbranch_scc1 L1_e1
    buffer_load_dwordx4 v[28:31], v140, s[60:63], s80 offen nt
    buffer_load_dwordx3 v[32:34], v141, s[60:63], s80 offen nt
L1_e1:
    s_cselect_b64 exec, -1, 0
    s_add_u32 s52, s10, 0x400000
    s_addc_u32 s53, s11, 0
    s_cbranch_execz L1_e2
    buffer_store_dwordx4 v[184:187], v158, s[52:55], s85 offen sc1
L1_e2:
    s_mov_b64 exec, -1
    v_lshlrev_b32 v215, 2, v0
    v_add_u32 v215, 108672, v215
    ds_write_b32 v215, v184
    s_load_dwordx2 s[24:25], s[0:1], 16
    s_load_dwordx2 s[32:33], s[0:1], 48
    s_load_dwordx2 s[36:37], s[0:1], 56
    s_load_dwordx2 s[40:41], s[0:1], 64
    s_and_b32 s91, s2, 7
    s_lshl_b32 s91, s91, 5
    s_lshr_b32 s89, s2, 3
    s_add_u32 s89, s89, s91
    s_mul_i32 s90, s89, 49
    s_mov_b32 s18, 0x186a00
    s_mov_b32 s19, 0x20000
    s_mov_b32 s66, 0x4880
    s_mov_b32 s67, 0x20000
    s_mov_b32 s22, 0x124f8
    s_mov_b32 s23, 0x20000
    s_mov_b32 s70, 0x100
    s_mov_b32 s71, 0x20000
    s_cmp_lg_u32 s88, 7
    s_cbranch_scc1 L1_e3
    v_lshrrev_b32 v216, 4, v1
    v_xor_b32 v216, v216, v1
    v_lshlrev_b32 v216, 4, v216
    v_xor_b32 v217, 64, v216
    s_mov_b32 m0, 84096
    s_mov_b32 s92, 8192
    buffer_load_dwordx4 v158, s[64:67], s92 offen offset:0 lds
    buffer_load_dwordx4 v158, s[64:67], s92 offen offset:1024 lds
    buffer_load_dwordx4 v158, s[64:67], s92 offen offset:2048 lds
    buffer_load_dwordx4 v158, s[64:67], s92 offen offset:3072 lds
    s_mov_b32 m0, 88192
    s_mov_b32 s92, 12288
    buffer_load_dwordx4 v158, s[64:67], s92 offen offset:0 lds
    buffer_load_dwordx4 v158, s[64:67], s92 offen offset:1024 lds
    buffer_load_dwordx4 v158, s[64:67], s92 offen offset:2048 lds
    buffer_load_dwordx4 v158, s[64:67], s92 offen offset:3072 lds
    s_mov_b32 m0, 96384
    s_lshl_b32 s92, s90, 7
    buffer_load_dwordx4 v216, s[16:19], s92 offen offset:0  lds
    buffer_load_dwordx4 v217, s[16:19], s92 offen offset:1024  lds
    buffer_load_dwordx4 v216, s[16:19], s92 offen offset:2048  lds
    buffer_load_dwordx4 v217, s[16:19], s92 offen offset:3072  lds
    s_mov_b32 m0, 100480
    s_add_u32 s92, s92, 4096
    buffer_load_dwordx4 v216, s[16:19], s92 offen offset:0  lds
    buffer_load_dwordx4 v217, s[16:19], s92 offen offset:1024  lds
    buffer_load_dwordx4 v216, s[16:19], s92 offen offset:2048  lds
    s_lshr_b32 s92, s2, 3
    s_mul_i32 s92, s92, 2432
    v_lshlrev_b32 v217, 7, v1
    s_mov_b64 exec, 0x7ffff
    buffer_load_dword v239, v217, s[20:23], s92 offen
    s_mov_b64 exec, -1
L1_e3:
    s_cmp_eq_u32 s88, 7
    s_waitcnt lgkmcnt(0)
    s_barrier
    s_cbranch_scc1 L1_e4
    buffer_load_dwordx4 v[36:39], v140, s[56:59], s80 offen nt
    buffer_load_dwordx3 v[40:42], v141, s[56:59], s80 offen nt
L1_e4:
    v_and_b32 v216, 7, v1
    v_and_b32 v142, 3, v1
    v_lshlrev_b32 v142, 7, v142
    v_lshlrev_b32 v238, 11, v216
    v_add_u32 v238, 129152, v238
    v_lshlrev_b32 v237, 3, v216
    v_lshlrev_b32 v209, 4, v216
    v_lshlrev_b32 v240, 5, v216
    v_subrev_u32 v218, 2048, v238
    ds_write_b32 v237, v218 offset:0
    s_sub_u32 s91, 3200000, s80
    v_cmp_gt_u32 s[72:73], s91, v140
    v_cmp_gt_u32 s[74:75], s91, v141
    v_lshlrev_b32 v124, 18, v140
    v_add_u32 v125, 0x100000, v124
    v_add_u32 v126, 0x200000, v124
    v_add_u32 v127, 0x300000, v124
    v_lshlrev_b32 v128, 18, v141
    v_add_u32 v129, 0x100000, v128
    v_add_u32 v130, 0x200000, v128
    v_mov_b32 v156, 4
    v_add_u32 v144, 108672, v158
    s_mov_b32 s81, 684785
    s_mov_b32 s82, -65
    v_mov_b32 v44, v144
    v_mov_b32 v45, v144
    v_mov_b32 v46, v144
    v_mov_b32 v47, v144
    v_mov_b32 v48, v144
    v_mov_b32 v49, v144
    v_mov_b32 v50, v144
    s_mov_b32 s26, 0xc3500
    s_mov_b32 s27, 0x20000
    s_mov_b32 s34, 0x80
    s_mov_b32 s35, 0x20000
    s_mov_b32 s38, 0x4000
    s_mov_b32 s39, 0x20000
    s_mov_b32 s42, 0x186a00
    s_mov_b32 s43, 0x20000
    s_or_b32 s25, s25, 0x200000
    s_add_u32 s44, s40, 0x186a00
    s_addc_u32 s45, s41, 0
    s_mov_b32 s46, 0x124f8
    s_mov_b32 s47, 0x20000
    s_mov_b32 s48, s10
    s_mov_b32 s49, s11
    s_mov_b32 s50, 0x310000
    s_mov_b32 s51, 0x20000
    s_add_u32 s28, s10, 0x4ff400
    s_addc_u32 s29, s11, 0
    s_mov_b32 s30, 0x187600
    s_mov_b32 s31, 0x20000
    s_mov_b32 s12, 0xbfb8aa3b
    s_mov_b32 s13, 0xbf31f149
    s_mov_b32 s14, 0xffff0000
    s_lshl_b32 s95, s88, 12
    s_add_u32 s95, s95, 75904
    s_mov_b32 s96, 0x1fff80
    s_mov_b32 s4, 1024
    s_mov_b32 s5, 2048
    s_mov_b32 s6, 3072
    s_mov_b32 s8, 0
    s_mov_b32 s15, 0
    s_mov_b32 s9, -1
    s_lshl_b32 s94, s88, 11
    s_add_u32 s94, s94, 108672
    s_mul_i32 s93, s88, 6
    v_lshrrev_b32 v3, 5, v1
    v_lshlrev_b32 v3, 4, v3
    v_lshrrev_b32 v215, 4, v1
    v_bfe_u32 v218, v1, 2, 2
    s_and_b32 s91, s88, 3
    s_lshl_b32 s91, s91, 5
    s_lshr_b32 s92, s88, 2
    s_lshl_b32 s92, s92, 5
    v_lshl_add_u32 v216, v215, 3, v218
    v_and_b32 v217, 3, v1
    v_lshlrev_b32 v217, 3, v217
    v_lshl_add_u32 v230, v216, 5, v217
    v_add_u32 v230, s95, v230
    v_lshl_add_u32 v145, v216, 7, v217
    v_add_u32 v145, 84096, v145
    v_add_u32 v145, s91, v145
    v_and_or_b32 v223, v1, 15, s92
    v_lshlrev_b32 v216, 7, v223
    v_lshl_add_u32 v217, v215, 3, s91
    v_add_u32 v148, v216, v217
    s_lshl_b32 s92, s90, 7
    v_add_u32 v233, s92, v148
    v_lshl_add_u32 v148, v223, 4, v148
    v_add_u32 v148, 127104, v148
    v_bfe_u32 v218, v1, 1, 3
    v_lshlrev_b32 v218, 4, v218
    v_add_u32 v216, 96384, v216
    v_xad_u32 v147, v217, v218, v216
    v_lshlrev_b32 v215, 4, v215
    v_xad_u32 v146, v215, v218, v216
    s_cmp_eq_u32 s88, 7
    s_cbranch_scc1 L1_bout
    s_mov_b32 s91, 108672
    s_waitcnt vmcnt(3)
    s_mov_b64 exec, s[72:73]
    v_lshl_add_u32 v215, v28, 10, v142
    v_mul_hi_u32_u24 v215, s81, v215
    v_lshrrev_b32 v216, 3, v215
    v_lshl_add_u32 v44, v216, 2, s91
    ds_add_rtn_u32 v52, v44, v156
    v_lshl_add_u32 v215, v215, 1, v28
    v_mad_i32_i24 v28, v216, s82, v215
    v_lshl_add_u32 v215, v29, 10, v142
    v_mul_hi_u32_u24 v215, s81, v215
    v_lshrrev_b32 v216, 3, v215
    v_lshl_add_u32 v45, v216, 2, s91
    ds_add_rtn_u32 v53, v45, v156
    v_lshl_add_u32 v215, v215, 1, v29
    v_mad_i32_i24 v29, v216, s82, v215
    v_lshl_add_u32 v215, v30, 10, v142
    v_mul_hi_u32_u24 v215, s81, v215
    v_lshrrev_b32 v216, 3, v215
    v_lshl_add_u32 v46, v216, 2, s91
    ds_add_rtn_u32 v54, v46, v156
    v_lshl_add_u32 v215, v215, 1, v30
    v_mad_i32_i24 v30, v216, s82, v215
    v_lshl_add_u32 v215, v31, 10, v142
    v_mul_hi_u32_u24 v215, s81, v215
    v_lshrrev_b32 v216, 3, v215
    v_lshl_add_u32 v47, v216, 2, s91
    ds_add_rtn_u32 v55, v47, v156
    v_lshl_add_u32 v215, v215, 1, v31
    v_mad_i32_i24 v31, v216, s82, v215
    s_waitcnt vmcnt(2)
    s_mov_b64 exec, s[74:75]
    v_lshl_add_u32 v215, v32, 10, v142
    v_mul_hi_u32_u24 v215, s81, v215
    v_lshrrev_b32 v216, 3, v215
    v_lshl_add_u32 v48, v216, 2, s91
    ds_add_rtn_u32 v56, v48, v156
    v_lshl_add_u32 v215, v215, 1, v32
    v_mad_i32_i24 v32, v216, s82, v215
    v_lshl_add_u32 v215, v33, 10, v142
    v_mul_hi_u32_u24 v215, s81, v215
    v_lshrrev_b32 v216, 3, v215
    v_lshl_add_u32 v49, v216, 2, s91
    ds_add_rtn_u32 v57, v49, v156
    v_lshl_add_u32 v215, v215, 1, v33
    v_mad_i32_i24 v33, v216, s82, v215
    v_lshl_add_u32 v215, v34, 10, v142
    v_mul_hi_u32_u24 v215, s81, v215
    v_lshrrev_b32 v216, 3, v215
    v_lshl_add_u32 v50, v216, 2, s91
    ds_add_rtn_u32 v58, v50, v156
    v_lshl_add_u32 v215, v215, 1, v34
    v_mad_i32_i24 v34, v216, s82, v215
    s_mov_b64 exec, -1
    s_lshl_b32 s91, s88, 10
    s_add_u32 m0, s91, 75904
    s_add_u32 s92, s91, 16384
    buffer_load_dwordx4 v158, s[64:67], s91 offen lds
    s_cmp_lt_u32 s88, 3
    s_cselect_b32 s92, s92, 7168
    s_add_u32 m0, s92, 75904
    s_cmp_lt_u32 s88, 4
    s_cselect_b64 exec, -1, 0
    buffer_load_dwordx4 v158, s[64:67], s92 offen lds
    s_mov_b64 exec, -1
    s_waitcnt lgkmcnt(0)
    s_barrier
    ds_read_b128 v[132:135], v144
    s_waitcnt lgkmcnt(0)
    v_add_u32 v138, v132, v133
    v_add_u32 v139, v138, v134
    v_add_u32 v215, v139, v135
    v_add_u32 v124, v124, v28
    v_add_u32 v125, v125, v29
    v_add_u32_dpp v143, v215, v215 row_shr:1 row_mask:0xf bank_mask:0xf bound_ctrl:1
    v_add_u32 v126, v126, v30
    s_mov_b32 s91, 110720
    v_add_u32_dpp v143, v143, v143 row_shr:2 row_mask:0xf bank_mask:0xf bound_ctrl:1
    v_add_u32 v127, v127, v31
    s_add_u32 s81, s80, 7168
    v_add_u32_dpp v143, v143, v143 row_shr:4 row_mask:0xf bank_mask:0xf bound_ctrl:1
    v_add_u32 v128, v128, v32
    v_add_u32 v218, s91, v140
    v_add_u32_dpp v143, v143, v143 row_shr:8 row_mask:0xf bank_mask:0xf bound_ctrl:1
    v_add_u32 v129, v129, v33
    v_cmp_gt_u32 vcc, 336, v0
    v_add_u32_dpp v143, v143, v143 row_bcast:15 row_mask:0xa bank_mask:0xf
    v_add_u32 v130, v130, v34
    s_nop 0
    v_add_u32_dpp v143, v143, v143 row_bcast:31 row_mask:0xc bank_mask:0xf
    v_sub_u32 v136, v143, v215
    v_add_u32 v137, v136, v132
    v_add_u32 v138, v136, v138
    v_add_u32 v139, v136, v139
    ds_write_b128 v144, v[136:139] offset:1024
    ds_read_b32 v28, v44 offset:1024
    ds_read_b32 v29, v45 offset:1024
    ds_read_b32 v30, v46 offset:1024
    ds_read_b32 v31, v47 offset:1024
    ds_read_b32 v32, v48 offset:1024
    ds_read_b32 v33, v49 offset:1024
    ds_read_b32 v34, v50 offset:1024
    s_waitcnt vmcnt(2)
    v_lshl_add_u32 v36, v36, 6, v124
    v_lshl_add_u32 v37, v37, 6, v125
    v_lshl_add_u32 v38, v38, 6, v126
    v_lshl_add_u32 v39, v39, 6, v127
    v_lshl_add_u32 v40, v40, 6, v128
    v_lshl_add_u32 v41, v41, 6, v129
    v_lshl_add_u32 v42, v42, 6, v130
    s_mov_b64 exec, s[72:73]
    s_waitcnt lgkmcnt(6)
    v_add3_u32 v28, v28, v52, s91
    ds_write_b32 v28, v36
    s_waitcnt lgkmcnt(6)
    v_add3_u32 v29, v29, v53, s91
    ds_write_b32 v29, v37
    s_waitcnt lgkmcnt(6)
    v_add3_u32 v30, v30, v54, s91
    ds_write_b32 v30, v38
    s_waitcnt lgkmcnt(6)
    v_add3_u32 v31, v31, v55, s91
    ds_write_b32 v31, v39
    s_mov_b64 exec, s[74:75]
    s_waitcnt lgkmcnt(6)
    v_add3_u32 v32, v32, v56, s91
    ds_write_b32 v32, v40
    s_waitcnt lgkmcnt(6)
    v_add3_u32 v33, v33, v57, s91
    ds_write_b32 v33, v41
    s_waitcnt lgkmcnt(6)
    v_add3_u32 v34, v34, v58, s91
    ds_write_b32 v34, v42
    s_mov_b64 exec, -1
    s_waitcnt lgkmcnt(0)
    s_barrier
    ds_read_b128 v[28:31], v218
    ds_read_b128 v[32:35], v218 offset:7168
    s_waitcnt lgkmcnt(1)
    buffer_store_dwordx4 v[28:31], v140, s[48:51], s80 offen sc1
    s_mov_b64 exec, vcc
    s_waitcnt lgkmcnt(0)
    buffer_store_dwordx4 v[32:35], v140, s[48:51], s81 offen sc1
    s_mov_b64 exec, -1
    s_branch L1_j3
L1_bout:
    s_and_b32 s91, s2, 24
    s_lshl_b32 s91, s91, 3
    v_mov_b32 v215, 1
    s_mov_b64 exec, 1
    s_waitcnt vmcnt(16)
    buffer_atomic_add v215, v184, s[68:71], s91 offen sc1
    s_mov_b64 exec, -1
    v_lshrrev_b32 v215, 5, v1
    v_bfe_u32 v216, v1, 2, 2
    v_lshl_add_u32 v216, v215, 3, v216
    v_bfe_u32 v217, v1, 4, 1
    v_lshl_add_u32 v216, v216, 2, v217
    v_and_b32 v217, 3, v1
    v_lshl_add_u32 v216, v216, 2, v217
    v_lshlrev_b32 v216, 3, v216
    v_add_u32 v143, 84096, v216
    v_and_b32 v217, 31, v1
    v_bfe_u32 v216, v1, 1, 3
    v_xor_b32 v216, v216, v215
    v_lshl_add_u32 v216, v217, 3, v216
    v_lshlrev_b32 v216, 4, v216
    v_add_u32 v160, 96384, v216
    v_xor_b32 v161, 32, v160
    v_xor_b32 v162, 64, v160
    v_xor_b32 v163, 0x60, v160
    v_mul_u32_u24 v217, 144, v217
    v_lshl_add_u32 v217, v215, 3, v217
    v_add_u32 v144, 127104, v217
    v_lshrrev_b32 v218, 3, v1
    v_lshl_add_u32 v218, v218, 4, v158
    v_add_u32 v218, 127104, v218
    s_lshl_b32 s92, s90, 7
    v_add_u32 v141, s92, v158
    s_mov_b32 s92, 7168
    s_setprio 1
    s_waitcnt vmcnt(2)
    ds_read_b128 v[28:31], v160
    ds_read_b64_tr_b16 v[92:93], v143 offset:0
    ds_read_b64_tr_b16 v[94:95], v143 offset:512
    ds_read_b64_tr_b16 v[96:97], v143 offset:64
    ds_read_b64_tr_b16 v[98:99], v143 offset:576
    ds_read_b128 v[32:35], v161
    ds_read_b64_tr_b16 v[100:101], v143 offset:2048
    ds_read_b64_tr_b16 v[102:103], v143 offset:2560
    ds_read_b64_tr_b16 v[104:105], v143 offset:2112
    ds_read_b64_tr_b16 v[106:107], v143 offset:2624
    ds_read_b128 v[36:39], v162
    ds_read_b64_tr_b16 v[108:109], v143 offset:4096
    ds_read_b64_tr_b16 v[110:111], v143 offset:4608
    ds_read_b64_tr_b16 v[112:113], v143 offset:4160
    ds_read_b64_tr_b16 v[114:115], v143 offset:4672
    ds_read_b128 v[40:43], v163
    ds_read_b64_tr_b16 v[116:117], v143 offset:6144
    ds_read_b64_tr_b16 v[118:119], v143 offset:6656
    ds_read_b64_tr_b16 v[120:121], v143 offset:6208
    ds_read_b64_tr_b16 v[122:123], v143 offset:6720
    ds_read_b128 v[44:47], v160 offset:4096
    ds_read_b128 v[48:51], v161 offset:4096
    ds_read_b128 v[52:55], v162 offset:4096
    ds_read_b128 v[56:59], v163 offset:4096
    s_barrier
    s_waitcnt lgkmcnt(4)
    v_mfma_f32_32x32x16_bf16 v[60:75], v[92:95], v[28:31], 0
    v_mfma_f32_32x32x16_bf16 v[60:75], v[100:103], v[32:35], v[60:75]
    v_mfma_f32_32x32x16_bf16 v[60:75], v[108:111], v[36:39], v[60:75]
    v_mfma_f32_32x32x16_bf16 v[60:75], v[116:119], v[40:43], v[60:75]
    v_mfma_f32_32x32x16_bf16 v[76:91], v[96:99], v[28:31], 0
    v_mfma_f32_32x32x16_bf16 v[76:91], v[104:107], v[32:35], v[76:91]
    v_mfma_f32_32x32x16_bf16 v[76:91], v[112:115], v[36:39], v[76:91]
    v_mfma_f32_32x32x16_bf16 v[76:91], v[120:123], v[40:43], v[76:91]
    s_waitcnt lgkmcnt(0)
    s_nop 5
    v_mfma_f32_32x32x16_bf16 v[124:139], v[92:95], v[44:47], 0
    v_mul_f32 v60, s12, v60
    v_mul_f32 v61, s12, v61
    v_mul_f32 v62, s12, v62
    v_mul_f32 v63, s12, v63
    v_cvt_pk_bf16_f32 v60, v60, v61
    v_cvt_pk_bf16_f32 v61, v62, v63
    ds_write_b64 v144, v[60:61] offset:0
    v_mfma_f32_32x32x16_bf16 v[124:139], v[100:103], v[48:51], v[124:139]
    v_mul_f32 v64, s12, v64
    v_mul_f32 v65, s12, v65
    v_mul_f32 v66, s12, v66
    v_mul_f32 v67, s12, v67
    v_cvt_pk_bf16_f32 v64, v64, v65
    v_cvt_pk_bf16_f32 v65, v66, v67
    ds_write_b64 v144, v[64:65] offset:16
    v_mfma_f32_32x32x16_bf16 v[124:139], v[108:111], v[52:55], v[124:139]
    v_mul_f32 v68, s12, v68
    v_mul_f32 v69, s12, v69
    v_mul_f32 v70, s12, v70
    v_mul_f32 v71, s12, v71
    v_cvt_pk_bf16_f32 v68, v68, v69
    v_cvt_pk_bf16_f32 v69, v70, v71
    ds_write_b64 v144, v[68:69] offset:32
    v_mfma_f32_32x32x16_bf16 v[124:139], v[116:119], v[56:59], v[124:139]
    v_mul_f32 v72, s12, v72
    v_mul_f32 v73, s12, v73
    v_mul_f32 v74, s12, v74
    v_mul_f32 v75, s12, v75
    v_cvt_pk_bf16_f32 v72, v72, v73
    v_cvt_pk_bf16_f32 v73, v74, v75
    ds_write_b64 v144, v[72:73] offset:48
    v_mfma_f32_32x32x16_bf16 v[12:27], v[96:99], v[44:47], 0
    v_mul_f32 v76, s12, v76
    v_mul_f32 v77, s12, v77
    v_mul_f32 v78, s12, v78
    v_mul_f32 v79, s12, v79
    v_cvt_pk_bf16_f32 v76, v76, v77
    v_cvt_pk_bf16_f32 v77, v78, v79
    ds_write_b64 v144, v[76:77] offset:64
    v_mfma_f32_32x32x16_bf16 v[12:27], v[104:107], v[48:51], v[12:27]
    v_mul_f32 v80, s12, v80
    v_mul_f32 v81, s12, v81
    v_mul_f32 v82, s12, v82
    v_mul_f32 v83, s12, v83
    v_cvt_pk_bf16_f32 v80, v80, v81
    v_cvt_pk_bf16_f32 v81, v82, v83
    ds_write_b64 v144, v[80:81] offset:80
    v_mfma_f32_32x32x16_bf16 v[12:27], v[112:115], v[52:55], v[12:27]
    v_mul_f32 v84, s12, v84
    v_mul_f32 v85, s12, v85
    v_mul_f32 v86, s12, v86
    v_mul_f32 v87, s12, v87
    v_cvt_pk_bf16_f32 v84, v84, v85
    v_cvt_pk_bf16_f32 v85, v86, v87
    ds_write_b64 v144, v[84:85] offset:96
    v_mfma_f32_32x32x16_bf16 v[12:27], v[120:123], v[56:59], v[12:27]
    v_mul_f32 v88, s12, v88
    v_mul_f32 v89, s12, v89
    v_mul_f32 v90, s12, v90
    v_mul_f32 v91, s12, v91
    v_cvt_pk_bf16_f32 v88, v88, v89
    v_cvt_pk_bf16_f32 v89, v90, v91
    ds_write_b64 v144, v[88:89] offset:112
    v_mul_f32 v124, s12, v124
    v_mul_f32 v125, s12, v125
    v_mul_f32 v126, s12, v126
    v_mul_f32 v127, s12, v127
    v_cvt_pk_bf16_f32 v124, v124, v125
    v_cvt_pk_bf16_f32 v125, v126, v127
    ds_write_b64 v144, v[124:125] offset:4608
    v_pk_mul_f32 v[128:129], v[128:129], s[12:13] op_sel_hi:[1,0]
    v_pk_mul_f32 v[130:131], v[130:131], s[12:13] op_sel_hi:[1,0]
    v_cvt_pk_bf16_f32 v128, v128, v129
    v_cvt_pk_bf16_f32 v129, v130, v131
    ds_write_b64 v144, v[128:129] offset:4624
    v_pk_mul_f32 v[132:133], v[132:133], s[12:13] op_sel_hi:[1,0]
    v_pk_mul_f32 v[134:135], v[134:135], s[12:13] op_sel_hi:[1,0]
    v_cvt_pk_bf16_f32 v132, v132, v133
    v_cvt_pk_bf16_f32 v133, v134, v135
    ds_write_b64 v144, v[132:133] offset:4640
    v_pk_mul_f32 v[136:137], v[136:137], s[12:13] op_sel_hi:[1,0]
    v_pk_mul_f32 v[138:139], v[138:139], s[12:13] op_sel_hi:[1,0]
    v_cvt_pk_bf16_f32 v136, v136, v137
    v_cvt_pk_bf16_f32 v137, v138, v139
    ds_write_b64 v144, v[136:137] offset:4656
    v_pk_mul_f32 v[12:13], v[12:13], s[12:13] op_sel_hi:[1,0]
    v_pk_mul_f32 v[14:15], v[14:15], s[12:13] op_sel_hi:[1,0]
    v_cvt_pk_bf16_f32 v12, v12, v13
    v_cvt_pk_bf16_f32 v13, v14, v15
    ds_write_b64 v144, v[12:13] offset:4672
    v_pk_mul_f32 v[16:17], v[16:17], s[12:13] op_sel_hi:[1,0]
    v_pk_mul_f32 v[18:19], v[18:19], s[12:13] op_sel_hi:[1,0]
    v_cvt_pk_bf16_f32 v16, v16, v17
    v_cvt_pk_bf16_f32 v17, v18, v19
    ds_write_b64 v144, v[16:17] offset:4688
    v_pk_mul_f32 v[20:21], v[20:21], s[12:13] op_sel_hi:[1,0]
    v_pk_mul_f32 v[22:23], v[22:23], s[12:13] op_sel_hi:[1,0]
    v_cvt_pk_bf16_f32 v20, v20, v21
    v_cvt_pk_bf16_f32 v21, v22, v23
    ds_write_b64 v144, v[20:21] offset:4704
    v_pk_mul_f32 v[24:25], v[24:25], s[12:13] op_sel_hi:[1,0]
    v_pk_mul_f32 v[26:27], v[26:27], s[12:13] op_sel_hi:[1,0]
    v_cvt_pk_bf16_f32 v24, v24, v25
    v_cvt_pk_bf16_f32 v25, v26, v27
    ds_write_b64 v144, v[24:25] offset:4720
    ds_read_b128 v[92:95], v218 offset:0
    ds_read_b128 v[96:99], v218 offset:1152
    ds_read_b128 v[100:103], v218 offset:2304
    ds_read_b128 v[104:107], v218 offset:3456
    ds_read_b128 v[108:111], v218 offset:4608
    ds_read_b128 v[112:115], v218 offset:5760
    ds_read_b128 v[116:119], v218 offset:6912
    s_waitcnt lgkmcnt(6)
    buffer_store_dwordx4 v[92:95], v141, s[28:31], s6 offen offset:0 sc1
    s_waitcnt lgkmcnt(5)
    buffer_store_dwordx4 v[96:99], v141, s[28:31], s6 offen offset:1024 sc1
    s_waitcnt lgkmcnt(4)
    buffer_store_dwordx4 v[100:103], v141, s[28:31], s6 offen offset:2048 sc1
    s_waitcnt lgkmcnt(3)
    buffer_store_dwordx4 v[104:107], v141, s[28:31], s6 offen offset:3072 sc1
    s_waitcnt lgkmcnt(2)
    buffer_store_dwordx4 v[108:111], v141, s[28:31], s92 offen offset:0 sc1
    s_waitcnt lgkmcnt(1)
    buffer_store_dwordx4 v[112:115], v141, s[28:31], s92 offen offset:1024 sc1
    s_waitcnt lgkmcnt(0)
    s_mov_b64 exec, 0xff
    buffer_store_dwordx4 v[116:119], v141, s[28:31], s92 offen offset:2048 sc1
    s_mov_b64 exec, -1
    s_setprio 0
    s_barrier
L1_j3:
    v_bfrev_b32 v215, 1
    v_lshl_or_b32 v132, v132, 16, v136
    v_or_b32 v124, v215, v132
    v_lshl_or_b32 v133, v133, 16, v137
    v_or_b32 v125, v215, v133
    v_lshl_or_b32 v134, v134, 16, v138
    v_or_b32 v126, v215, v134
    v_lshl_or_b32 v135, v135, 16, v139
    v_or_b32 v127, v215, v135
    v_bfe_u32 v218, v1, 2, 2
    v_and_b32 v215, 3, v1
    v_bfe_u32 v192, v1, 4, 1
    v_lshlrev_b32 v192, 5, v192
    v_lshl_add_u32 v192, v215, 3, v192
    v_lshl_add_u32 v216, v3, 5, v192
    v_lshl_add_u32 v198, v218, 6, v216
    v_add_u32 v198, s94, v198
    v_lshrrev_b32 v217, 1, v218
    v_lshl_add_u32 v208, v217, 7, v216
    v_add_u32 v208, s95, v208
    v_and_b32 v149, 1, v218
    v_cmp_eq_u32 vcc, 1, v149
    v_mov_b32 v150, 159936
    v_and_b32 v149, 1, v215
    v_cndmask_b32 v208, v150, v208, vcc
    v_lshl_add_u32 v150, v149, 6, v150
    v_lshrrev_b32 v149, 1, v215
    v_lshl_add_u32 v150, v149, 8, v150
    v_lshl_add_u32 v150, v218, 10, v150
    ds_write_b64 v150, v[184:185]
    v_lshl_add_u32 v149, v3, 6, v192
    v_lshl_add_u32 v149, v218, 7, v149
    v_add_u32 v149, 75904, v149
    v_lshl_add_u32 v216, v217, 2, v215
    v_add_u32 v216, s93, v216
    v_bfe_u32 v150, v216, 1, 3
    v_lshlrev_b32 v150, 4, v150
    v_xor_b32 v150, v150, v3
    v_lshl_add_u32 v150, v216, 7, v150
    v_add_u32 v150, 96384, v150
    v_and_b32 v216, 32, v192
    v_lshl_add_u32 v216, v217, 6, v216
    v_add3_u32 v229, v216, v3, s94
    v_lshl_add_u32 v228, v1, 2, s94
    s_and_b32 s91, s88, 3
    s_lshl_b32 s91, s91, 5
    v_and_b32 v216, 1, v1
    v_lshl_add_u32 v216, v216, 4, s91
    v_lshrrev_b32 v231, 1, v1
    v_lshl_add_u32 v231, v231, 7, v216
    v_lshrrev_b32 v232, 2, v1
    v_bfe_u32 v217, v1, 1, 1
    v_lshl_add_u32 v232, v217, 5, v232
    v_add_u32 v232, 48, v232
    v_lshl_add_u32 v232, v232, 7, v216
    v_and_b32 v234, 31, v1
    v_lshlrev_b32 v234, 1, v234
    v_add_u32 v151, 92288, v234
    v_bfrev_b32 v227, 1
    v_bfrev_b32 v2, 1
    v_bfrev_b32 v224, 1
    v_and_b32 v215, 31, v1
    v_lshrrev_b32 v216, 2, v215
    v_and_b32 v188, 3, v215
    v_lshrrev_b32 v218, 1, v216
    v_cmp_eq_u32 vcc, v218, v188
    v_and_b32 v218, 1, v216
    v_lshlrev_b32 v218, 4, v218
    v_mov_b32 v196, 0x3f80
    v_lshlrev_b32 v218, v218, v196
    v_cndmask_b32 v218, 0, v218, vcc
    v_lshlrev_b32 v192, 16, v218
    v_cmp_eq_u32 vcc, 3, v188
    s_lshl_b32 s91, s88, 8
    s_add_u32 s91, s91, 125056
    v_cndmask_b32 v218, v218, v192, vcc
    v_mov_b32 v201, s91
    v_lshl_add_u32 v236, v215, 2, v201
    ds_write_b32 v236, v218
    v_cmp_gt_u32 vcc, 7, v216
    s_add_u32 s91, s93, s90
    v_add_u32 v216, s91, v216
    v_mov_b32 v218, 12500
    v_cndmask_b32 v216, v218, v216, vcc
    v_mul_u32_u24 v216, 6, v216
    v_lshl_add_u32 v235, v188, 1, v216
    v_lshl_add_u32 v199, v215, 6, s94
    v_mov_b32 v197, 0
    v_mov_b32 v191, 0xdddddddd
    v_and_b32 v152, 15, v1
    v_lshlrev_b32 v152, 2, v152
    v_lshrrev_b32 v215, 4, v1
    v_mul_u32_u24 v154, 3136, v215
    s_lshl_b32 s91, s88, 2
    v_add3_u32 v240, v240, v215, s91
    s_lshl_b32 s91, s89, 2
    v_mul_u32_u24 v153, 12544, v240
    v_lshl_add_u32 v240, v240, 10, s91
    s_lshl_b32 s92, s88, 11
    s_add_u32 s92, s92, 127104
    v_and_or_b32 v202, v1, 56, s92
    v_bfe_u32 v203, v1, 3, 1
    v_lshl_add_u32 v203, v203, 2, v237
    v_and_b32 v204, 16, v1
    v_lshl_add_u32 v203, v204, 2, v203
    v_add_u32 v203, s92, v203
    v_lshl_add_u32 v204, v3, 3, v203
    s_mul_i32 s92, s88, 9216
    s_add_u32 s92, s92, 0
    s_add_u32 m0, s92, 128
    s_nop 0
    buffer_load_dwordx4 v158, s[20:23], s92 offen offset:0 lds
    buffer_load_dwordx4 v158, s[20:23], s92 offen offset:1024 lds
    buffer_load_dwordx4 v158, s[20:23], s92 offen offset:2048 lds
    buffer_load_dwordx4 v158, s[20:23], s92 offen offset:3072 lds
    s_cmp_eq_u32 s88, 0
    s_cselect_b64 exec, -1, 0
    s_waitcnt vmcnt(4) lgkmcnt(0)
    s_barrier
    buffer_store_dwordx4 v[124:127], v158, s[52:55], s85 offen sc1
    s_mov_b64 exec, -1
    s_cmp_ge_u32 s88, 4
    s_cbranch_scc1 L1_y1
    s_mul_i32 s92, s88, 9216
    s_add_u32 s92, s92, 4096
    s_add_u32 m0, s92, 128
    s_nop 0
    buffer_load_dwordx4 v158, s[20:23], s92 offen offset:0 lds
    buffer_load_dwordx4 v158, s[20:23], s92 offen offset:1024 lds
    buffer_load_dwordx4 v158, s[20:23], s92 offen offset:2048 lds
    buffer_load_dwordx4 v158, s[20:23], s92 offen offset:3072 lds
    s_add_u32 m0, m0, 4096
    s_add_u32 s92, s92, 4096
    buffer_load_dwordx4 v158, s[20:23], s92 offen offset:0 lds
    s_lshl_b32 s92, s88, 10
    s_add_u32 s92, s92, 73728
    s_add_u32 m0, s92, 128
    s_cmp_lt_u32 s88, 2
    s_cselect_b64 exec, -1, 0
    buffer_load_dwordx4 v158, s[20:23], s92 offen lds
    s_mov_b64 exec, -1
L1_y1:
    v_xor_b32 v217, 64, v146
    ds_read_b128 v[164:167], v146 offset:0
    ds_read_b128 v[168:171], v217 offset:0
    ds_read_b64 v[180:181], v147 offset:0
    ds_read_b128 v[172:175], v146 offset:2048
    ds_read_b128 v[176:179], v217 offset:2048
    ds_read_b64 v[182:183], v147 offset:2048
    v_xor_b32 v216, 32, v150
    v_xor_b32 v217, 64, v150
    v_xor_b32 v218, 0x60, v150
    ds_read_b128 v[44:47], v150
    ds_read_b128 v[48:51], v216
    ds_read_b128 v[52:55], v217
    ds_read_b128 v[56:59], v218
    ds_read_b64_tr_b16 v[4:5], v149 offset:16512
    ds_read_b64_tr_b16 v[6:7], v149 offset:17024
    ds_read_b64_tr_b16 v[8:9], v149 offset:16576
    ds_read_b64_tr_b16 v[10:11], v149 offset:17088
    ds_read_u16_d16_hi v212, v151
    ds_read_u16_d16_hi v213, v151 offset:64
    ds_read_b64_tr_b16 v[92:93], v149 offset:0
    ds_read_b64_tr_b16 v[94:95], v149 offset:512
    ds_read_b64_tr_b16 v[96:97], v149 offset:64
    ds_read_b64_tr_b16 v[98:99], v149 offset:576
    ds_read_b64_tr_b16 v[100:101], v149 offset:2048
    ds_read_b64_tr_b16 v[102:103], v149 offset:2560
    ds_read_b64_tr_b16 v[104:105], v149 offset:2112
    ds_read_b64_tr_b16 v[106:107], v149 offset:2624
    ds_read_b64_tr_b16 v[108:109], v149 offset:4096
    ds_read_b64_tr_b16 v[110:111], v149 offset:4608
    ds_read_b64_tr_b16 v[112:113], v149 offset:4160
    ds_read_b64_tr_b16 v[114:115], v149 offset:4672
    ds_read_b64_tr_b16 v[116:117], v149 offset:6144
    ds_read_b64_tr_b16 v[118:119], v149 offset:6656
    ds_read_b64_tr_b16 v[120:121], v149 offset:6208
    ds_read_b64_tr_b16 v[122:123], v149 offset:6720
    v_lshlrev_b32 v205, 6, v1
    s_cmp_eq_u32 s88, 6
    s_cselect_b64 exec, 15, 0
    buffer_load_dword v143, v205, s[68:71], 0 offen sc1
    s_mov_b64 exec, -1
    s_cmp_lt_u32 s88, 4
    s_cbranch_scc1 L1_cdone
    s_mul_i32 s92, s88, 9216
    s_add_u32 s92, s92, 4096
    s_add_u32 m0, s92, 128
    s_nop 0
    buffer_load_dwordx4 v158, s[20:23], s92 offen offset:0 lds
    buffer_load_dwordx4 v158, s[20:23], s92 offen offset:1024 lds
    buffer_load_dwordx4 v158, s[20:23], s92 offen offset:2048 lds
    buffer_load_dwordx4 v158, s[20:23], s92 offen offset:3072 lds
    s_add_u32 m0, m0, 4096
    s_add_u32 s92, s92, 4096
    buffer_load_dwordx4 v158, s[20:23], s92 offen offset:0 lds
    s_cmp_lg_u32 s88, 6
    s_cbranch_scc1 L1_cdone
    s_mov_b32 s91, 0
    s_mov_b64 exec, 15
    s_waitcnt vmcnt(5)
L1_cpoll:
    v_cmp_gt_u32 vcc, 64, v143
    s_cbranch_vccz L1_cok
    buffer_load_dword v143, v205, s[68:71], 0 offen sc1
    s_add_u32 s91, s91, 1
    s_cmp_lt_u32 s91, 4096
    s_waitcnt vmcnt(0)
    s_cbranch_scc1 L1_cpoll
    v_bfrev_b32 v215, 8
    ds_or_b32 v184, v215 offset:0
L1_cok:
    s_mov_b64 exec, -1
L1_cdone:
    s_barrier
    buffer_load_dword v210, v240, s[52:55], 0 offen sc1
    s_waitcnt lgkmcnt(0)
    v_mfma_f32_32x32x16_bf16 v[60:75], v[44:47], v[92:95], 0
    v_lshlrev_b32 v216, 16, v4
    v_and_b32 v218, s14, v4
    v_mul_f32 v216, s12, v216
    v_mul_f32 v218, s12, v218
    v_cvt_pk_bf16_f32 v4, v216, v218
    v_mfma_f32_32x32x16_bf16 v[60:75], v[48:51], v[100:103], v[60:75]
    v_lshlrev_b32 v216, 16, v5
    v_and_b32 v218, s14, v5
    v_mul_f32 v216, s12, v216
    v_mul_f32 v218, s12, v218
    v_cvt_pk_bf16_f32 v5, v216, v218
    v_mfma_f32_32x32x16_bf16 v[60:75], v[52:55], v[108:111], v[60:75]
    v_lshlrev_b32 v216, 16, v6
    v_and_b32 v218, s14, v6
    v_mul_f32 v216, s12, v216
    v_mul_f32 v218, s12, v218
    v_cvt_pk_bf16_f32 v6, v216, v218
    v_mfma_f32_32x32x16_bf16 v[60:75], v[56:59], v[116:119], v[60:75]
    v_lshlrev_b32 v216, 16, v7
    v_and_b32 v218, s14, v7
    v_mul_f32 v216, s12, v216
    v_mul_f32 v218, s12, v218
    v_cvt_pk_bf16_f32 v7, v216, v218
    v_mfma_f32_32x32x16_bf16 v[76:91], v[44:47], v[96:99], 0
    v_lshlrev_b32 v216, 16, v8
    v_and_b32 v218, s14, v8
    v_mul_f32 v216, s12, v216
    v_mul_f32 v218, s12, v218
    v_cvt_pk_bf16_f32 v8, v216, v218
    v_mfma_f32_32x32x16_bf16 v[76:91], v[48:51], v[104:107], v[76:91]
    v_lshlrev_b32 v216, 16, v9
    v_and_b32 v218, s14, v9
    v_mul_f32 v216, s12, v216
    v_mul_f32 v218, s12, v218
    v_cvt_pk_bf16_f32 v9, v216, v218
    v_mfma_f32_32x32x16_bf16 v[76:91], v[52:55], v[112:115], v[76:91]
    v_lshlrev_b32 v216, 16, v10
    v_and_b32 v218, s14, v10
    v_mul_f32 v216, s12, v216
    v_mul_f32 v218, s12, v218
    v_cvt_pk_bf16_f32 v10, v216, v218
    v_mfma_f32_32x32x16_bf16 v[76:91], v[56:59], v[120:123], v[76:91]
    v_lshlrev_b32 v216, 16, v11
    v_and_b32 v218, s14, v11
    v_mul_f32 v216, s12, v216
    v_mul_f32 v218, s12, v218
    v_cvt_pk_bf16_f32 v11, v216, v218
    v_lshl_add_u32 v200, v3, 1, v199
    ds_write_b128 v200, v[184:187]
    ds_write_b128 v200, v[184:187] offset:16
    ds_write2st64_b32 v203, v191, v191 offset1:64
    v_mov_b32 v192, 0x186a0e
    v_bfrev_b32 v193, 1
    s_mov_b32 s91, 0
    s_waitcnt vmcnt(0)
    s_branch L2_pw
L2_poll:
    s_mov_b64 exec, vcc
    buffer_load_dword v210, v240, s[52:55], 0 offen sc1
    s_add_u32 s91, s91, 1
    s_waitcnt vmcnt(0)
L2_pw:
    v_cmp_le_i32 vcc, 0, v210
    s_cbranch_vccz L2_seen
    s_cmp_lt_u32 s91, 4096
    s_cbranch_scc1 L2_poll
    v_bfrev_b32 v215, 8
    ds_or_b32 v184, v215 offset:0
L2_seen:
    s_mov_b64 exec, -1
    v_add_u32_sdwa v215, v210, v153 dst_sel:DWORD src0_sel:WORD_0 src1_sel:DWORD
    v_bfe_u32 v155, v210, 16, 15
    s_nop 0
    v_add_u32_dpp v84, v215, v152 row_newbcast:0 row_mask:0xf bank_mask:0xf
    buffer_load_dword v124, v84, s[48:51], 0 offen sc1
    v_add_u32_dpp v85, v215, v152 row_newbcast:1 row_mask:0xf bank_mask:0xf
    buffer_load_dword v126, v85, s[48:51], 0 offen sc1
    v_add_u32_dpp v86, v215, v152 row_newbcast:2 row_mask:0xf bank_mask:0xf
    buffer_load_dword v128, v86, s[48:51], 0 offen sc1
    v_add_u32_dpp v87, v215, v152 row_newbcast:3 row_mask:0xf bank_mask:0xf
    buffer_load_dword v130, v87, s[48:51], 0 offen sc1
    v_add_u32_dpp v88, v215, v152 row_newbcast:4 row_mask:0xf bank_mask:0xf
    buffer_load_dword v132, v88, s[48:51], 0 offen sc1
    v_add_u32_dpp v89, v215, v152 row_newbcast:5 row_mask:0xf bank_mask:0xf
    buffer_load_dword v134, v89, s[48:51], 0 offen sc1
    v_add_u32_dpp v90, v215, v152 row_newbcast:6 row_mask:0xf bank_mask:0xf
    buffer_load_dword v136, v90, s[48:51], 0 offen sc1
    v_add_u32_dpp v91, v215, v152 row_newbcast:7 row_mask:0xf bank_mask:0xf
    buffer_load_dword v138, v91, s[48:51], 0 offen sc1
    v_sub_u32_dpp v241, v155, v152 row_newbcast:0 row_mask:0xf bank_mask:0xf
    v_sub_u32_dpp v242, v155, v152 row_newbcast:1 row_mask:0xf bank_mask:0xf
    v_sub_u32_dpp v243, v155, v152 row_newbcast:2 row_mask:0xf bank_mask:0xf
    v_sub_u32_dpp v244, v155, v152 row_newbcast:3 row_mask:0xf bank_mask:0xf
    v_sub_u32_dpp v245, v155, v152 row_newbcast:4 row_mask:0xf bank_mask:0xf
    v_sub_u32_dpp v246, v155, v152 row_newbcast:5 row_mask:0xf bank_mask:0xf
    v_sub_u32_dpp v247, v155, v152 row_newbcast:6 row_mask:0xf bank_mask:0xf
    v_sub_u32_dpp v248, v155, v152 row_newbcast:7 row_mask:0xf bank_mask:0xf
    v_cmp_lt_i32 s[58:59], 64, v241
    v_cmp_lt_i32 s[56:57], 0, v241
    v_cmp_lt_i32 s[62:63], 64, v242
    v_cmp_lt_i32 s[60:61], 0, v242
    v_cmp_lt_i32 s[66:67], 64, v243
    v_cmp_lt_i32 s[64:65], 0, v243
    v_cmp_lt_i32 s[70:71], 64, v244
    v_cmp_lt_i32 s[68:69], 0, v244
    v_cmp_lt_i32 s[74:75], 64, v245
    v_cmp_lt_i32 s[72:73], 0, v245
    v_cmp_lt_i32 s[78:79], 64, v246
    v_cmp_lt_i32 s[76:77], 0, v246
    v_cmp_lt_i32 s[82:83], 64, v247
    v_cmp_lt_i32 s[80:81], 0, v247
    v_cmp_lt_i32 s[86:87], 64, v248
    v_cmp_lt_i32 s[84:85], 0, v248
    s_mov_b64 exec, s[58:59]
    s_cbranch_execz L2_rsa0
    buffer_load_dword v125, v84, s[48:51], 0 offen offset:64 sc1
L2_rsa0:
    s_mov_b64 exec, s[62:63]
    s_cbranch_execz L2_rsa1
    buffer_load_dword v127, v85, s[48:51], 0 offen offset:64 sc1
L2_rsa1:
    s_mov_b64 exec, s[66:67]
    s_cbranch_execz L2_rsa2
    buffer_load_dword v129, v86, s[48:51], 0 offen offset:64 sc1
L2_rsa2:
    s_mov_b64 exec, s[70:71]
    s_cbranch_execz L2_rsa3
    buffer_load_dword v131, v87, s[48:51], 0 offen offset:64 sc1
L2_rsa3:
    s_mov_b64 exec, s[74:75]
    s_cbranch_execz L2_rsa4
    buffer_load_dword v133, v88, s[48:51], 0 offen offset:64 sc1
L2_rsa4:
    s_mov_b64 exec, s[78:79]
    s_cbranch_execz L2_rsa5
    buffer_load_dword v135, v89, s[48:51], 0 offen offset:64 sc1
L2_rsa5:
    s_mov_b64 exec, s[82:83]
    s_cbranch_execz L2_rsa6
    buffer_load_dword v137, v90, s[48:51], 0 offen offset:64 sc1
L2_rsa6:
    s_mov_b64 exec, s[86:87]
    s_cbranch_execz L2_rsa7
    buffer_load_dword v139, v91, s[48:51], 0 offen offset:64 sc1
L2_rsa7:
    s_mov_b64 exec, -1
    v_subrev_u32 v155, 128, v155
    s_mul_i32 s91, s88, 12544
    s_waitcnt lgkmcnt(0)
    s_barrier
    ds_read_u16_d16_hi v214, v235 offset:128
    s_and_b32 s92, s2, -8
    s_add_u32 s92, s92, s88
    s_mul_i32 s92, s92, 6272
    v_lshl_add_u32 v200, v1, 7, s92
    s_mov_b32 exec_lo, 0x1ffffff
    s_mov_b32 exec_hi, 0x0
    buffer_load_dword v239, v200, s[28:31], 0 offen offset:3072 sc1
    s_mov_b64 exec, -1
    s_waitcnt lgkmcnt(0)
    ds_write_b32 v236, v214 offset:128
    s_mov_b32 m0, s95
    s_mov_b32 s7, 0
    s_waitcnt vmcnt(1)
    s_mov_b64 exec, s[56:57]
    v_and_b32 v108, 56, v124
    ds_add_rtn_u32 v108, v108, v156 offset:0
    v_lshrrev_b32 v92, 20, v124
    v_lshlrev_b32 v124, 1, v124
    v_add3_u32 v92, v92, v154, s91
    s_mov_b64 exec, s[58:59]
    s_cbranch_execz L2_iaa1
    v_and_b32 v109, 56, v125
    ds_add_rtn_u32 v109, v109, v156 offset:0
    v_lshrrev_b32 v93, 20, v125
    v_lshlrev_b32 v125, 1, v125
    v_add3_u32 v93, v93, v154, s91
L2_iaa1:
    s_add_u32 s91, s91, 100352
    s_barrier
    s_mov_b64 exec, s[60:61]
    v_and_b32 v110, 56, v126
    ds_add_rtn_u32 v110, v110, v156 offset:0
    v_lshrrev_b32 v94, 20, v126
    v_lshlrev_b32 v126, 1, v126
    v_add3_u32 v94, v94, v154, s91
    s_mov_b64 exec, s[62:63]
    s_cbranch_execz L2_iaa3
    v_and_b32 v111, 56, v127
    ds_add_rtn_u32 v111, v111, v156 offset:0
    v_lshrrev_b32 v95, 20, v127
    v_lshlrev_b32 v127, 1, v127
    v_add3_u32 v95, v95, v154, s91
L2_iaa3:
    s_add_u32 s91, s91, 100352
    s_waitcnt lgkmcnt(1)
    s_mov_b64 exec, s[56:57]
    v_min_u32 v108, 143484, v108
    ds_write2st64_b32 v108, v124, v92 offset1:64
    s_mov_b64 exec, s[58:59]
    s_cbranch_execz L2_iba1
    v_min_u32 v109, 143484, v109
    ds_write2st64_b32 v109, v125, v93 offset1:64
L2_iba1:
    s_barrier
    s_mov_b64 exec, s[64:65]
    v_and_b32 v112, 56, v128
    ds_add_rtn_u32 v112, v112, v156 offset:0
    v_lshrrev_b32 v96, 20, v128
    v_lshlrev_b32 v128, 1, v128
    v_add3_u32 v96, v96, v154, s91
    s_mov_b64 exec, s[66:67]
    s_cbranch_execz L2_iaa5
    v_and_b32 v113, 56, v129
    ds_add_rtn_u32 v113, v113, v156 offset:0
    v_lshrrev_b32 v97, 20, v129
    v_lshlrev_b32 v129, 1, v129
    v_add3_u32 v97, v97, v154, s91
L2_iaa5:
    s_add_u32 s91, s91, 100352
    s_waitcnt lgkmcnt(2)
    s_mov_b64 exec, s[60:61]
    v_min_u32 v110, 143484, v110
    ds_write2st64_b32 v110, v126, v94 offset1:64
    s_mov_b64 exec, s[62:63]
    s_cbranch_execz L2_iba3
    v_min_u32 v111, 143484, v111
    ds_write2st64_b32 v111, v127, v95 offset1:64
L2_iba3:
    s_barrier
    s_cmp_ge_u32 s88, 3
    s_cbranch_scc1 L2_h3
    s_mov_b64 exec, -1
    ds_read_b32 v2, v203 offset:16384
    ds_read2_b64 v[160:163], v202 offset1:8
L2_h3:
    s_mov_b64 exec, s[68:69]
    v_and_b32 v114, 56, v130
    ds_add_rtn_u32 v114, v114, v156 offset:0
    v_lshrrev_b32 v98, 20, v130
    v_lshlrev_b32 v130, 1, v130
    v_add3_u32 v98, v98, v154, s91
    s_mov_b64 exec, s[70:71]
    s_cbranch_execz L2_iaa7
    v_and_b32 v115, 56, v131
    ds_add_rtn_u32 v115, v115, v156 offset:0
    v_lshrrev_b32 v99, 20, v131
    v_lshlrev_b32 v131, 1, v131
    v_add3_u32 v99, v99, v154, s91
L2_iaa7:
    s_add_u32 s91, s91, 100352
    s_waitcnt lgkmcnt(2)
    s_mov_b64 exec, s[64:65]
    v_min_u32 v112, 143484, v112
    ds_write2st64_b32 v112, v128, v96 offset1:64
    s_mov_b64 exec, s[66:67]
    s_cbranch_execz L2_iba5
    v_min_u32 v113, 143484, v113
    ds_write2st64_b32 v113, v129, v97 offset1:64
L2_iba5:
    s_cmp_ge_u32 s88, 3
    s_cbranch_scc1 L2_nea3
    s_mov_b64 exec, -1
    s_waitcnt lgkmcnt(2)
    v_or3_b32 v211, v160, v161, v162
    v_or_b32 v211, v211, v163
    v_lshl_or_b32 v211, v211, 31, v2
    v_cmp_gt_i32 s[98:99], 0, v211
    v_and_or_b32 v160, v160, s96, v209
    v_and_or_b32 v161, v161, s96, v209
    v_and_or_b32 v162, v162, s96, v209
    v_and_or_b32 v163, v163, s96, v209
    s_cmp_lg_u64 s[98:99], 0
    s_cbranch_scc1 L2_nea3
    buffer_load_dwordx4 v160, s[28:31], s6 offen offset:0 sc1 lds
    buffer_load_dwordx4 v161, s[28:31], s5 offen offset:1024 sc1 lds
    buffer_load_dwordx4 v162, s[28:31], s4 offen offset:2048 sc1 lds
    buffer_load_dwordx4 v163, s[28:31], 0 offen offset:3072 sc1 lds
    buffer_load_dwordx4 v[140:143], v[2:3], s[24:27], 0 idxen offen
    s_mov_b32 s7, 1
L2_nea3:
    s_barrier
    s_mov_b64 exec, s[72:73]
    v_and_b32 v116, 56, v132
    ds_add_rtn_u32 v116, v116, v156 offset:0
    v_lshrrev_b32 v100, 20, v132
    v_lshlrev_b32 v132, 1, v132
    v_add3_u32 v100, v100, v154, s91
    s_mov_b64 exec, s[74:75]
    s_cbranch_execz L2_iaa9
    v_and_b32 v117, 56, v133
    ds_add_rtn_u32 v117, v117, v156 offset:0
    v_lshrrev_b32 v101, 20, v133
    v_lshlrev_b32 v133, 1, v133
    v_add3_u32 v101, v101, v154, s91
L2_iaa9:
    s_add_u32 s91, s91, 100352
    s_waitcnt lgkmcnt(2)
    s_mov_b64 exec, s[68:69]
    v_min_u32 v114, 143484, v114
    ds_write2st64_b32 v114, v130, v98 offset1:64
    s_mov_b64 exec, s[70:71]
    s_cbranch_execz L2_iba7
    v_min_u32 v115, 143484, v115
    ds_write2st64_b32 v115, v131, v99 offset1:64
L2_iba7:
    s_barrier
    s_mov_b64 exec, s[76:77]
    v_and_b32 v118, 56, v134
    ds_add_rtn_u32 v118, v118, v156 offset:0
    v_lshrrev_b32 v102, 20, v134
    v_lshlrev_b32 v134, 1, v134
    v_add3_u32 v102, v102, v154, s91
    s_mov_b64 exec, s[78:79]
    s_cbranch_execz L2_iaa11
    v_and_b32 v119, 56, v135
    ds_add_rtn_u32 v119, v119, v156 offset:0
    v_lshrrev_b32 v103, 20, v135
    v_lshlrev_b32 v135, 1, v135
    v_add3_u32 v103, v103, v154, s91
L2_iaa11:
    s_add_u32 s91, s91, 100352
    s_waitcnt lgkmcnt(2)
    s_mov_b64 exec, s[72:73]
    v_min_u32 v116, 143484, v116
    ds_write2st64_b32 v116, v132, v100 offset1:64
    s_mov_b64 exec, s[74:75]
    s_cbranch_execz L2_iba9
    v_min_u32 v117, 143484, v117
    ds_write2st64_b32 v117, v133, v101 offset1:64
L2_iba9:
    s_barrier
    s_cmp_lt_u32 s88, 3
    s_cbranch_scc1 L2_h6
    s_cmp_ge_u32 s88, 6
    s_cbranch_scc1 L2_h6
    s_mov_b64 exec, -1
    ds_read_b32 v2, v203 offset:16384
    ds_read2_b64 v[160:163], v202 offset1:8
L2_h6:
    s_mov_b64 exec, s[80:81]
    v_and_b32 v120, 56, v136
    ds_add_rtn_u32 v120, v120, v156 offset:0
    v_lshrrev_b32 v104, 20, v136
    v_lshlrev_b32 v136, 1, v136
    v_add3_u32 v104, v104, v154, s91
    s_mov_b64 exec, s[82:83]
    s_cbranch_execz L2_iaa13
    v_and_b32 v121, 56, v137
    ds_add_rtn_u32 v121, v121, v156 offset:0
    v_lshrrev_b32 v105, 20, v137
    v_lshlrev_b32 v137, 1, v137
    v_add3_u32 v105, v105, v154, s91
L2_iaa13:
    s_add_u32 s91, s91, 100352
    s_waitcnt lgkmcnt(2)
    s_mov_b64 exec, s[76:77]
    v_min_u32 v118, 143484, v118
    ds_write2st64_b32 v118, v134, v102 offset1:64
    s_mov_b64 exec, s[78:79]
    s_cbranch_execz L2_iba11
    v_min_u32 v119, 143484, v119
    ds_write2st64_b32 v119, v135, v103 offset1:64
L2_iba11:
    s_cmp_lt_u32 s88, 3
    s_cbranch_scc1 L2_nea6
    s_cmp_ge_u32 s88, 6
    s_cbranch_scc1 L2_nea6
    s_mov_b64 exec, -1
    s_waitcnt lgkmcnt(2)
    v_or3_b32 v211, v160, v161, v162
    v_or_b32 v211, v211, v163
    v_lshl_or_b32 v211, v211, 31, v2
    v_cmp_gt_i32 s[98:99], 0, v211
    v_and_or_b32 v160, v160, s96, v209
    v_and_or_b32 v161, v161, s96, v209
    v_and_or_b32 v162, v162, s96, v209
    v_and_or_b32 v163, v163, s96, v209
    s_cmp_lg_u64 s[98:99], 0
    s_cbranch_scc1 L2_nea6
    buffer_load_dwordx4 v160, s[28:31], s6 offen offset:0 sc1 lds
    buffer_load_dwordx4 v161, s[28:31], s5 offen offset:1024 sc1 lds
    buffer_load_dwordx4 v162, s[28:31], s4 offen offset:2048 sc1 lds
    buffer_load_dwordx4 v163, s[28:31], 0 offen offset:3072 sc1 lds
    buffer_load_dwordx4 v[140:143], v[2:3], s[24:27], 0 idxen offen
    s_mov_b32 s7, 1
L2_nea6:
    s_barrier
    s_mov_b64 exec, s[84:85]
    v_and_b32 v122, 56, v138
    ds_add_rtn_u32 v122, v122, v156 offset:0
    v_lshrrev_b32 v106, 20, v138
    v_lshlrev_b32 v138, 1, v138
    v_add3_u32 v106, v106, v154, s91
    s_mov_b64 exec, s[86:87]
    s_cbranch_execz L2_iaa15
    v_and_b32 v123, 56, v139
    ds_add_rtn_u32 v123, v123, v156 offset:0
    v_lshrrev_b32 v107, 20, v139
    v_lshlrev_b32 v139, 1, v139
    v_add3_u32 v107, v107, v154, s91
L2_iaa15:
    s_waitcnt lgkmcnt(2)
    s_mov_b64 exec, s[80:81]
    v_min_u32 v120, 143484, v120
    ds_write2st64_b32 v120, v136, v104 offset1:64
    s_mov_b64 exec, s[82:83]
    s_cbranch_execz L2_iba13
    v_min_u32 v121, 143484, v121
    ds_write2st64_b32 v121, v137, v105 offset1:64
L2_iba13:
    s_waitcnt lgkmcnt(1)
    s_mov_b64 exec, s[84:85]
    v_min_u32 v122, 143484, v122
    ds_write2st64_b32 v122, v138, v106 offset1:64
    s_mov_b64 exec, s[86:87]
    s_cbranch_execz L2_iba15
    v_min_u32 v123, 143484, v123
    ds_write2st64_b32 v123, v139, v107 offset1:64
L2_iba15:
    s_mov_b64 exec, -1
    v_cmp_lt_i32 vcc, 0, v155
    s_cbranch_vccnz L2_more
L2_insdone:
    s_mov_b32 s56, 0
L2_after_insert:
    s_lshl_b32 s92, s88, 11
    s_add_u32 s92, s92, 127104
    s_mov_b32 m0, s95
    s_cmp_lg_u32 s7, 0
    s_waitcnt lgkmcnt(0)
    s_barrier
    ds_read_b32 v215, v237 offset:0
    s_cbranch_scc1 L2_ned
    ds_read_b32 v2, v203 offset:16384
    ds_read2_b64 v[160:163], v202 offset1:8
    s_waitcnt lgkmcnt(0)
    v_or3_b32 v211, v160, v161, v162
    v_or_b32 v211, v211, v163
    v_lshl_or_b32 v211, v211, 31, v2
    v_cmp_gt_i32 s[98:99], 0, v211
    v_and_or_b32 v160, v160, s96, v209
    v_and_or_b32 v161, v161, s96, v209
    v_and_or_b32 v162, v162, s96, v209
    v_and_or_b32 v163, v163, s96, v209
    s_cmp_lg_u64 s[98:99], 0
    s_cbranch_scc1 L2_ned
    buffer_load_dwordx4 v160, s[28:31], s6 offen offset:0 sc1 lds
    buffer_load_dwordx4 v161, s[28:31], s5 offen offset:1024 sc1 lds
    buffer_load_dwordx4 v162, s[28:31], s4 offen offset:2048 sc1 lds
    buffer_load_dwordx4 v163, s[28:31], 0 offen offset:3072 sc1 lds
    buffer_load_dwordx4 v[140:143], v[2:3], s[24:27], 0 idxen offen
    s_mov_b32 s7, 1
L2_ned:
    s_waitcnt lgkmcnt(0)
    v_cmp_gt_u32 vcc, v215, v238
    v_readlane_b32 s91, v215, s88
    s_cbranch_vccnz L2_overflow
    s_sub_u32 s93, s91, s92
    s_add_u32 s94, s93, 255
    s_andn2_b32 s94, s94, 255
    s_add_u32 s94, s94, s92
    v_lshl_add_u32 v218, v1, 2, s91
    v_cmp_gt_u32 vcc, s94, v218
    s_add_u32 s93, s93, 127
    s_and_b32 s59, s93, 64
    s_lshr_b32 s93, s93, 7
    s_mov_b64 exec, vcc
    ds_write2st64_b32 v218, v192, v193 offset1:64
    s_mov_b64 exec, -1
    s_cmp_lg_u32 s7, 0
    s_cbranch_scc1 L2_issued
    s_cmp_eq_u32 s93, 0
    s_cbranch_scc1 L2_issued
    ds_read2_b64 v[160:163], v202 offset0:0 offset1:8
    ds_read_b32 v2, v203 offset:16384
    s_waitcnt lgkmcnt(0)
    v_and_or_b32 v160, v160, s96, v209
    v_and_or_b32 v161, v161, s96, v209
    v_and_or_b32 v162, v162, s96, v209
    v_and_or_b32 v163, v163, s96, v209
    buffer_load_dwordx4 v160, s[28:31], s6 offen offset:0 sc1 lds
    buffer_load_dwordx4 v161, s[28:31], s5 offen offset:1024 sc1 lds
    buffer_load_dwordx4 v162, s[28:31], s4 offen offset:2048 sc1 lds
    buffer_load_dwordx4 v163, s[28:31], 0 offen offset:3072 sc1 lds
    buffer_load_dwordx4 v[140:143], v[2:3], s[24:27], 0 idxen offen
L2_issued:
    ds_read_b32 v210, v204
    ds_read2_b64 v[160:163], v202 offset0:16 offset1:24
    ds_read_b32 v2, v203 offset:16512
    s_cmp_lg_u32 s15, 0
    s_cbranch_scc1 L2_once
    s_mov_b32 s15, 1
    v_cmp_lt_u32 vcc, 31, v1
    v_mfma_f32_32x32x16_bf16 v[28:43], v[184:187], v[184:187], 0
    v_mfma_f32_32x32x16_bf16 v[44:59], v[184:187], v[184:187], 0
    v_mul_f32 v60, s12, v60
    v_mul_f32 v61, s12, v61
    v_mul_f32 v62, s12, v62
    v_mul_f32 v63, s12, v63
    v_mul_f32 v64, s12, v64
    v_mul_f32 v65, s12, v65
    v_mul_f32 v66, s12, v66
    v_cvt_pk_bf16_f32 v215, v60, v61
    v_cndmask_b32 v12, v215, 0, vcc
    v_cndmask_b32 v20, 0, v215, vcc
    v_cvt_pk_bf16_f32 v215, v62, v63
    v_cndmask_b32 v13, v215, 0, vcc
    v_cndmask_b32 v21, 0, v215, vcc
    v_cvt_pk_bf16_f32 v215, v64, v65
    v_cndmask_b32 v14, v215, 0, vcc
    v_cndmask_b32 v22, 0, v215, vcc
    v_cvt_pk_bf16_f32 v215, v66, v212
    v_cndmask_b32 v15, v215, 0, vcc
    v_cndmask_b32 v23, 0, v215, vcc
    v_mul_f32 v76, s12, v76
    v_mul_f32 v77, s12, v77
    v_mul_f32 v78, s12, v78
    v_mul_f32 v79, s12, v79
    v_mul_f32 v80, s12, v80
    v_mul_f32 v81, s12, v81
    v_mul_f32 v82, s12, v82
    v_cvt_pk_bf16_f32 v215, v76, v77
    v_cndmask_b32 v16, v215, 0, vcc
    v_cndmask_b32 v24, 0, v215, vcc
    v_cvt_pk_bf16_f32 v215, v78, v79
    v_cndmask_b32 v17, v215, 0, vcc
    v_cndmask_b32 v25, 0, v215, vcc
    v_cvt_pk_bf16_f32 v215, v80, v81
    v_cndmask_b32 v18, v215, 0, vcc
    v_cndmask_b32 v26, 0, v215, vcc
    v_cvt_pk_bf16_f32 v215, v82, v213
    v_cndmask_b32 v19, v215, 0, vcc
    v_cndmask_b32 v27, 0, v215, vcc
    v_add_u32 v224, 16, v223
    v_and_b32 v215, 48, v1
    v_add_u32 v215, 108672, v215
    v_mul_u32_u24 v217, 43, v223
    v_lshrrev_b32 v217, 8, v217
    v_min_u32 v217, 7, v217
    v_mad_i32_i24 v218, v217, -6, v223
    v_min_u32 v218, 7, v218
    v_max_u32 v220, 1, v223
    v_mad_i32_i24 v220, v217, -6, v220
    v_cmp_eq_u32 vcc, 0, v220
    v_lshl_add_u32 v217, v217, 11, v215
    v_lshl_add_u32 v219, v218, 7, v217
    v_add_u32 v220, 896, v217
    v_subrev_u32 v217, 1280, v217
    v_cndmask_b32 v220, v220, v217, vcc
    v_mul_u32_u24 v217, 43, v224
    v_lshrrev_b32 v217, 8, v217
    v_min_u32 v217, 7, v217
    v_mad_i32_i24 v218, v217, -6, v224
    v_min_u32 v218, 7, v218
    v_max_u32 v222, 1, v224
    v_mad_i32_i24 v222, v217, -6, v222
    v_cmp_eq_u32 vcc, 0, v222
    v_lshl_add_u32 v217, v217, 11, v215
    v_lshl_add_u32 v221, v218, 7, v217
    v_add_u32 v222, 896, v217
    v_subrev_u32 v217, 1280, v217
    v_cndmask_b32 v222, v222, v217, vcc
    v_cmp_gt_u32 vcc, 49, v224
    v_add_u32 v224, 2048, v233
    v_bfrev_b32 v216, 1
    v_cndmask_b32 v224, v216, v224, vcc
    v_mul_u32_u24 v223, 171, v0
    v_lshrrev_b32 v223, 9, v223
    v_mad_i32_i24 v215, v223, -3, v0
    v_lshlrev_b32 v215, 2, v215
    v_add_u32 v215, 109696, v215
    v_min_u32 v223, 63, v223
    v_mul_u32_u24 v217, 43, v223
    v_lshrrev_b32 v217, 8, v217
    v_min_u32 v217, 7, v217
    v_mad_i32_i24 v218, v217, -6, v223
    v_min_u32 v218, 7, v218
    v_max_u32 v226, 1, v223
    v_mad_i32_i24 v226, v217, -6, v226
    v_cmp_eq_u32 vcc, 0, v226
    v_lshl_add_u32 v217, v217, 11, v215
    v_lshl_add_u32 v225, v218, 4, v217
    v_add_u32 v226, 112, v217
    v_subrev_u32 v217, 1952, v217
    v_cndmask_b32 v226, v226, v217, vcc
    s_mul_i32 s92, s90, 6
    v_lshl_add_u32 v227, v0, 1, s92
L2_once:
    s_sub_u32 s94, s93, 1
    s_cbranch_scc1 L2_notiles
    s_waitcnt lgkmcnt(0)
    v_and_b32 v211, 14, v210
    v_bfe_u32 v206, v210, 7, 14
    v_mul_u32_u24 v206, 6, v206
    v_lshl_add_u32 v205, v211, 3, v201
    ds_read_u16_d16_hi v212, v206 offset:128
    ds_read_u16_d16_hi v213, v206 offset:130
    ds_read_u16_d16_hi v214, v206 offset:132
    ds_read_b96 v[188:190], v205 offset:128
    ds_read_b128 v[148:151], v205
    v_lshl_add_u32 v200, v211, 2, v199
    v_and_or_b32 v160, v160, s96, v209
    v_and_or_b32 v161, v161, s96, v209
    v_and_or_b32 v162, v162, s96, v209
    v_and_or_b32 v163, v163, s96, v209
    v_mfma_f32_32x32x16_bf16 v[76:91], v[184:187], v[184:187], 0
    v_mov_b32 v152, 0
    v_mov_b32 v153, 0
    v_mov_b32 v154, 0
    v_mov_b32 v155, 0
    v_mov_b32 v156, 0
    v_mov_b32 v157, 0
    v_mov_b32 v158, 0
    v_mov_b32 v159, 0
    s_waitcnt lgkmcnt(0)
    v_sub_f32 v189, v189, v213
    v_sub_f32 v190, v190, v214
    v_sub_f32 v188, v188, v212
    v_cvt_pk_bf16_f32 v193, v189, v190
    v_cvt_pk_bf16_f32 v192, 1.0, v188
    v_lshlrev_b32 v189, 16, v193
    v_and_b32 v190, s14, v193
    v_and_b32 v188, s14, v192
    v_mul_f32 v207, v189, v189
    v_fmac_f32 v207, v190, v190
    v_fmac_f32 v207, v188, v188
    v_mul_f32 v207, s12, v207
    s_mov_b32 exec_hi, 0
    ds_write_b64 v200, v[192:193]
    s_mov_b32 exec_hi, -1
    v_cvt_pk_bf16_f32 v151, v151, v207
    s_waitcnt vmcnt(1)
    ds_read_b64_tr_b16 v[60:61], v208 offset:0
    ds_read_b64_tr_b16 v[62:63], v208 offset:256
    ds_read_b64_tr_b16 v[64:65], v208 offset:1024
    ds_read_b64_tr_b16 v[66:67], v208 offset:1280
    ds_read_b64_tr_b16 v[68:69], v208 offset:2048
    ds_read_b64_tr_b16 v[70:71], v208 offset:2304
    ds_read_b64_tr_b16 v[72:73], v208 offset:3072
    ds_read_b64_tr_b16 v[74:75], v208 offset:3328
    ds_read_b64_tr_b16 v[124:125], v208 offset:64
    ds_read_b64_tr_b16 v[126:127], v208 offset:320
    ds_read_b64_tr_b16 v[128:129], v208 offset:1088
    ds_read_b64_tr_b16 v[130:131], v208 offset:1344
    ds_read_b64_tr_b16 v[132:133], v208 offset:2112
    ds_read_b64_tr_b16 v[134:135], v208 offset:2368
    ds_read_b64_tr_b16 v[136:137], v208 offset:3136
    ds_read_b64_tr_b16 v[138:139], v208 offset:3392
    s_sub_u32 s94, s94, 1
    s_waitcnt lgkmcnt(0)
    v_mfma_f32_32x32x16_bf16 v[60:75], v[148:151], v[12:15], v[60:75]
    s_cbranch_scc1 L2_tailp
    buffer_load_dwordx4 v160, s[28:31], s6 offen offset:0 sc1 lds
    buffer_load_dwordx4 v161, s[28:31], s5 offen offset:1024 sc1 lds
    buffer_load_dwordx4 v162, s[28:31], s4 offen offset:2048 sc1 lds
    buffer_load_dwordx4 v163, s[28:31], 0 offen offset:3072 sc1 lds
    buffer_load_dwordx4 v[144:147], v[2:3], s[24:27], 0 idxen offen
    s_waitcnt vmcnt(5)
L2_contp:
    v_mfma_f32_32x32x16_bf16 v[60:75], v[140:143], v[4:7], v[60:75]
    ds_read2_b64 v[160:163], v202 offset0:32 offset1:40
    ds_read_b32 v2, v203 offset:16640
    ds_read_b32 v210, v204 offset:256
    s_nop 6
    s_cbranch_scc1 L2_fin0
.p2align 6
    s_nop 0
L2_loop:
    v_smfmac_f32_32x32x32_bf16 v[44:59], v[152:155], v[76:83], v191
    v_exp_f32 v92, v60
    v_exp_f32 v93, v61
    v_exp_f32 v94, v62
    v_exp_f32 v95, v63
    v_smfmac_f32_32x32x32_bf16 v[44:59], v[156:159], v[84:91], v191
    v_exp_f32 v96, v64
    v_exp_f32 v97, v65
    v_exp_f32 v98, v66
    v_exp_f32 v99, v67
    v_mfma_f32_32x32x16_bf16 v[76:91], v[148:151], v[16:19], v[124:139]
    v_exp_f32 v100, v68
    v_exp_f32 v101, v69
    v_exp_f32 v102, v70
    v_exp_f32 v103, v71
    v_mfma_f32_32x32x16_bf16 v[76:91], v[140:143], v[8:11], v[76:91]
    v_exp_f32 v104, v72
    v_exp_f32 v105, v73
    v_exp_f32 v106, v74
    v_exp_f32 v107, v75
    s_waitcnt lgkmcnt(0)
    v_and_or_b32 v160, v160, s96, v209
    v_mfma_f32_16x16x4_4b_bf16 v[92:107], v[196:197], v[196:197], v[92:107]
    ds_read_b64_tr_b16 v[152:153], v198 offset:0
    ds_read_b64_tr_b16 v[154:155], v198 offset:256
    ds_read_b64_tr_b16 v[156:157], v198 offset:1024
    ds_read_b64_tr_b16 v[158:159], v198 offset:1280
    s_mov_b32 exec_hi, 0
    ds_write_b64 v200, v[184:185]
    s_mov_b64 exec, s[8:9]
    ds_write_b64 v200, v[192:193]
    s_mov_b32 exec_lo, -1
    v_and_b32 v211, 14, v210
    v_bfe_u32 v206, v210, 7, 14
    v_mul_u32_u24 v206, 6, v206
    v_lshl_add_u32 v205, v211, 3, v201
    ds_read_u16_d16_hi v212, v206 offset:128
    ds_read_u16_d16_hi v213, v206 offset:130
    ds_read_u16_d16_hi v214, v206 offset:132
    ds_read_b96 v[188:190], v205 offset:128
    v_and_or_b32 v161, v161, s96, v209
    v_and_or_b32 v162, v162, s96, v209
    v_and_or_b32 v163, v163, s96, v209
    v_rcp_f32 v92, v92
    v_rcp_f32 v93, v93
    v_rcp_f32 v94, v94
    v_rcp_f32 v95, v95
    v_rcp_f32 v96, v96
    v_rcp_f32 v97, v97
    v_rcp_f32 v98, v98
    v_rcp_f32 v99, v99
    v_rcp_f32 v100, v100
    v_rcp_f32 v101, v101
    v_rcp_f32 v102, v102
    v_rcp_f32 v103, v103
    v_rcp_f32 v104, v104
    v_rcp_f32 v105, v105
    v_rcp_f32 v106, v106
    v_rcp_f32 v107, v107
    s_waitcnt lgkmcnt(0)
    v_pk_add_f32 v[188:189], v[188:189], v[212:213] neg_lo:[0,1] neg_hi:[0,1]
    v_sub_f32 v190, v190, v214
    v_cvt_pk_bf16_f32 v192, 1.0, v188
    v_cvt_pk_bf16_f32 v193, v189, v190
    v_dot2_f32_bf16 v207, v192, v192, -1.0
    v_dot2_f32_bf16 v207, v193, v193, v207
    v_pk_mul_f32 v[60:61], v[60:61], v[92:93]
    v_pk_mul_f32 v[62:63], v[62:63], v[94:95]
    v_pk_mul_f32 v[64:65], v[64:65], v[96:97]
    v_pk_mul_f32 v[66:67], v[66:67], v[98:99]
    v_pk_mul_f32 v[68:69], v[68:69], v[100:101]
    v_pk_mul_f32 v[70:71], v[70:71], v[102:103]
    v_pk_mul_f32 v[72:73], v[72:73], v[104:105]
    v_pk_mul_f32 v[74:75], v[74:75], v[106:107]
    v_smfmac_f32_32x32x32_bf16 v[28:43], v[152:155], v[60:67], v191
    v_exp_f32 v108, v76
    v_exp_f32 v109, v77
    v_exp_f32 v110, v78
    v_exp_f32 v111, v79
    v_smfmac_f32_32x32x32_bf16 v[28:43], v[156:159], v[68:75], v191
    v_exp_f32 v112, v80
    v_exp_f32 v113, v81
    v_exp_f32 v114, v82
    v_exp_f32 v115, v83
    s_setprio 0
    s_waitcnt vmcnt(1)
    ds_read_b64_tr_b16 v[60:61], v208 offset:0
    ds_read_b64_tr_b16 v[62:63], v208 offset:256
    ds_read_b64_tr_b16 v[64:65], v208 offset:1024
    ds_read_b64_tr_b16 v[66:67], v208 offset:1280
    ds_read_b64_tr_b16 v[68:69], v208 offset:2048
    ds_read_b64_tr_b16 v[70:71], v208 offset:2304
    ds_read_b64_tr_b16 v[72:73], v208 offset:3072
    ds_read_b64_tr_b16 v[74:75], v208 offset:3328
    ds_read_b64_tr_b16 v[124:125], v208 offset:64
    ds_read_b64_tr_b16 v[126:127], v208 offset:320
    ds_read_b64_tr_b16 v[128:129], v208 offset:1088
    ds_read_b64_tr_b16 v[130:131], v208 offset:1344
    ds_read_b64_tr_b16 v[132:133], v208 offset:2112
    ds_read_b64_tr_b16 v[134:135], v208 offset:2368
    ds_read_b64_tr_b16 v[136:137], v208 offset:3136
    ds_read_b64_tr_b16 v[138:139], v208 offset:3392
    v_exp_f32 v116, v84
    v_exp_f32 v117, v85
    v_exp_f32 v118, v86
    v_exp_f32 v119, v87
    v_exp_f32 v120, v88
    v_exp_f32 v121, v89
    v_exp_f32 v122, v90
    v_exp_f32 v123, v91
    s_waitcnt lgkmcnt(0)
    s_sub_u32 s94, s94, 1
    v_mfma_f32_16x16x4_4b_bf16 v[108:123], v[196:197], v[196:197], v[108:123]
    s_cbranch_scc1 L2_tail0
    buffer_load_dwordx4 v160, s[28:31], s6 offen offset:0 sc1 lds
    buffer_load_dwordx4 v161, s[28:31], s5 offen offset:1024 sc1 lds
    buffer_load_dwordx4 v162, s[28:31], s4 offen offset:2048 sc1 lds
    buffer_load_dwordx4 v163, s[28:31], 0 offen offset:3072 sc1 lds
    buffer_load_dwordx4 v[140:143], v[2:3], s[24:27], 0 idxen offen
    s_waitcnt vmcnt(5)
L2_cont0:
    ds_read2_b64 v[160:163], v202 offset0:48 offset1:56
    ds_read_b32 v2, v203 offset:16768
    s_nop 2
    v_rcp_f32 v108, v108
    v_rcp_f32 v109, v109
    v_rcp_f32 v110, v110
    v_rcp_f32 v111, v111
    v_mfma_f32_32x32x16_bf16 v[60:75], v[148:151], v[20:23], v[60:75]
    v_rcp_f32 v112, v112
    v_rcp_f32 v113, v113
    v_rcp_f32 v114, v114
    v_rcp_f32 v115, v115
    v_mfma_f32_32x32x16_bf16 v[60:75], v[144:147], v[4:7], v[60:75]
    v_rcp_f32 v116, v116
    v_rcp_f32 v117, v117
    v_rcp_f32 v118, v118
    v_rcp_f32 v119, v119
    s_setprio 1
    v_rcp_f32 v120, v120
    v_rcp_f32 v121, v121
    v_rcp_f32 v122, v122
    v_rcp_f32 v123, v123
    v_pk_mul_f32 v[76:77], v[76:77], v[108:109]
    v_pk_mul_f32 v[78:79], v[78:79], v[110:111]
    v_pk_mul_f32 v[80:81], v[80:81], v[112:113]
    v_pk_mul_f32 v[82:83], v[82:83], v[114:115]
    v_pk_mul_f32 v[84:85], v[84:85], v[116:117]
    v_pk_mul_f32 v[86:87], v[86:87], v[118:119]
    v_pk_mul_f32 v[88:89], v[88:89], v[120:121]
    v_pk_mul_f32 v[90:91], v[90:91], v[122:123]
    s_cbranch_scc1 L2_fin1
    v_smfmac_f32_32x32x32_bf16 v[44:59], v[152:155], v[76:83], v191
    v_exp_f32 v92, v60
    v_exp_f32 v93, v61
    v_exp_f32 v94, v62
    v_exp_f32 v95, v63
    v_smfmac_f32_32x32x32_bf16 v[44:59], v[156:159], v[84:91], v191
    v_exp_f32 v96, v64
    v_exp_f32 v97, v65
    v_exp_f32 v98, v66
    v_exp_f32 v99, v67
    v_mfma_f32_32x32x16_bf16 v[76:91], v[148:151], v[24:27], v[124:139]
    ds_read_b128 v[148:151], v205
    v_exp_f32 v100, v68
    v_exp_f32 v101, v69
    v_exp_f32 v102, v70
    v_exp_f32 v103, v71
    v_mfma_f32_32x32x16_bf16 v[76:91], v[144:147], v[8:11], v[76:91]
    v_exp_f32 v104, v72
    v_exp_f32 v105, v73
    v_exp_f32 v106, v74
    v_exp_f32 v107, v75
    s_waitcnt lgkmcnt(0)
    v_and_or_b32 v160, v160, s96, v209
    v_mfma_f32_16x16x4_4b_bf16 v[92:107], v[196:197], v[196:197], v[92:107]
    ds_read_b64_tr_b16 v[152:153], v198 offset:0
    ds_read_b64_tr_b16 v[154:155], v198 offset:256
    ds_read_b64_tr_b16 v[156:157], v198 offset:1024
    ds_read_b64_tr_b16 v[158:159], v198 offset:1280
    s_mov_b32 exec_lo, 0
    ds_write_b64 v200, v[184:185]
    s_mov_b32 exec_lo, -1
    v_lshl_add_u32 v200, v211, 2, v199
    s_mov_b32 exec_hi, 0
    ds_write_b64 v200, v[192:193]
    s_mov_b32 exec_hi, -1
    v_mul_f32 v207, s12, v207
    v_and_or_b32 v161, v161, s96, v209
    v_and_or_b32 v162, v162, s96, v209
    v_and_or_b32 v163, v163, s96, v209
    v_cvt_pk_bf16_f32 v151, v151, v207
    v_rcp_f32 v92, v92
    v_rcp_f32 v93, v93
    v_rcp_f32 v94, v94
    v_rcp_f32 v95, v95
    v_rcp_f32 v96, v96
    v_rcp_f32 v97, v97
    v_rcp_f32 v98, v98
    v_rcp_f32 v99, v99
    v_rcp_f32 v100, v100
    v_rcp_f32 v101, v101
    v_rcp_f32 v102, v102
    v_rcp_f32 v103, v103
    v_rcp_f32 v104, v104
    v_rcp_f32 v105, v105
    v_rcp_f32 v106, v106
    v_rcp_f32 v107, v107
    s_waitcnt lgkmcnt(2)
    v_pk_mul_f32 v[60:61], v[60:61], v[92:93]
    v_pk_mul_f32 v[62:63], v[62:63], v[94:95]
    v_pk_mul_f32 v[64:65], v[64:65], v[96:97]
    v_pk_mul_f32 v[66:67], v[66:67], v[98:99]
    v_pk_mul_f32 v[68:69], v[68:69], v[100:101]
    v_pk_mul_f32 v[70:71], v[70:71], v[102:103]
    v_pk_mul_f32 v[72:73], v[72:73], v[104:105]
    v_pk_mul_f32 v[74:75], v[74:75], v[106:107]
    v_smfmac_f32_32x32x32_bf16 v[28:43], v[152:155], v[60:67], v191
    v_exp_f32 v108, v76
    v_exp_f32 v109, v77
    v_exp_f32 v110, v78
    v_exp_f32 v111, v79
    v_smfmac_f32_32x32x32_bf16 v[28:43], v[156:159], v[68:75], v191
    v_exp_f32 v112, v80
    v_exp_f32 v113, v81
    v_exp_f32 v114, v82
    v_exp_f32 v115, v83
    s_setprio 0
    s_waitcnt vmcnt(1)
    ds_read_b64_tr_b16 v[60:61], v208 offset:0
    ds_read_b64_tr_b16 v[62:63], v208 offset:256
    ds_read_b64_tr_b16 v[64:65], v208 offset:1024
    ds_read_b64_tr_b16 v[66:67], v208 offset:1280
    ds_read_b64_tr_b16 v[68:69], v208 offset:2048
    ds_read_b64_tr_b16 v[70:71], v208 offset:2304
    ds_read_b64_tr_b16 v[72:73], v208 offset:3072
    ds_read_b64_tr_b16 v[74:75], v208 offset:3328
    ds_read_b64_tr_b16 v[124:125], v208 offset:64
    ds_read_b64_tr_b16 v[126:127], v208 offset:320
    ds_read_b64_tr_b16 v[128:129], v208 offset:1088
    ds_read_b64_tr_b16 v[130:131], v208 offset:1344
    ds_read_b64_tr_b16 v[132:133], v208 offset:2112
    ds_read_b64_tr_b16 v[134:135], v208 offset:2368
    ds_read_b64_tr_b16 v[136:137], v208 offset:3136
    ds_read_b64_tr_b16 v[138:139], v208 offset:3392
    v_exp_f32 v116, v84
    v_exp_f32 v117, v85
    v_exp_f32 v118, v86
    v_exp_f32 v119, v87
    v_exp_f32 v120, v88
    v_exp_f32 v121, v89
    v_exp_f32 v122, v90
    v_exp_f32 v123, v91
    s_waitcnt lgkmcnt(0)
    s_sub_u32 s94, s94, 1
    v_mfma_f32_16x16x4_4b_bf16 v[108:123], v[196:197], v[196:197], v[108:123]
    s_cbranch_scc1 L2_tail1
    buffer_load_dwordx4 v160, s[28:31], s6 offen offset:0 sc1 lds
    buffer_load_dwordx4 v161, s[28:31], s5 offen offset:1024 sc1 lds
    buffer_load_dwordx4 v162, s[28:31], s4 offen offset:2048 sc1 lds
    buffer_load_dwordx4 v163, s[28:31], 0 offen offset:3072 sc1 lds
    buffer_load_dwordx4 v[144:147], v[2:3], s[24:27], 0 idxen offen
    s_waitcnt vmcnt(5)
L2_cont1:
    ds_read2_b64 v[160:163], v202 offset0:64 offset1:72
    ds_read_b32 v2, v203 offset:16896
    ds_read_b32 v210, v204 offset:512
    v_add_u32 v202, 256, v202
    v_add_u32 v203, 256, v203
    v_add_u32 v204, 256, v204
    v_rcp_f32 v108, v108
    v_rcp_f32 v109, v109
    v_rcp_f32 v110, v110
    v_rcp_f32 v111, v111
    v_mfma_f32_32x32x16_bf16 v[60:75], v[148:151], v[12:15], v[60:75]
    v_rcp_f32 v112, v112
    v_rcp_f32 v113, v113
    v_rcp_f32 v114, v114
    v_rcp_f32 v115, v115
    v_mfma_f32_32x32x16_bf16 v[60:75], v[140:143], v[4:7], v[60:75]
    v_rcp_f32 v116, v116
    v_rcp_f32 v117, v117
    v_rcp_f32 v118, v118
    v_rcp_f32 v119, v119
    s_setprio 1
    v_rcp_f32 v120, v120
    v_rcp_f32 v121, v121
    v_rcp_f32 v122, v122
    v_rcp_f32 v123, v123
    v_pk_mul_f32 v[76:77], v[76:77], v[108:109]
    v_pk_mul_f32 v[78:79], v[78:79], v[110:111]
    v_pk_mul_f32 v[80:81], v[80:81], v[112:113]
    v_pk_mul_f32 v[82:83], v[82:83], v[114:115]
    v_pk_mul_f32 v[84:85], v[84:85], v[116:117]
    v_pk_mul_f32 v[86:87], v[86:87], v[118:119]
    v_pk_mul_f32 v[88:89], v[88:89], v[120:121]
    v_pk_mul_f32 v[90:91], v[90:91], v[122:123]
    s_cbranch_scc0 L2_loop
L2_fin0:
    v_smfmac_f32_32x32x32_bf16 v[44:59], v[152:155], v[76:83], v191
    s_cmp_eq_u32 s59, 0
    v_exp_f32 v92, v60
    v_exp_f32 v93, v61
    v_exp_f32 v94, v62
    v_exp_f32 v95, v63
    v_smfmac_f32_32x32x32_bf16 v[44:59], v[156:159], v[84:91], v191
    ds_read_b64_tr_b16 v[152:153], v198 offset:0
    ds_read_b64_tr_b16 v[154:155], v198 offset:256
    ds_read_b64_tr_b16 v[156:157], v198 offset:1024
    ds_read_b64_tr_b16 v[158:159], v198 offset:1280
    v_mfma_f32_32x32x16_bf16 v[76:91], v[148:151], v[16:19], v[124:139]
    v_exp_f32 v96, v64
    v_exp_f32 v97, v65
    v_exp_f32 v98, v66
    v_exp_f32 v99, v67
    v_mfma_f32_32x32x16_bf16 v[76:91], v[140:143], v[8:11], v[76:91]
    s_branch L2_finc
L2_fin1:
    v_smfmac_f32_32x32x32_bf16 v[44:59], v[152:155], v[76:83], v191
    s_cmp_eq_u32 s59, 0
    v_exp_f32 v92, v60
    v_exp_f32 v93, v61
    v_exp_f32 v94, v62
    v_exp_f32 v95, v63
    v_smfmac_f32_32x32x32_bf16 v[44:59], v[156:159], v[84:91], v191
    ds_read_b64_tr_b16 v[152:153], v198 offset:0
    ds_read_b64_tr_b16 v[154:155], v198 offset:256
    ds_read_b64_tr_b16 v[156:157], v198 offset:1024
    ds_read_b64_tr_b16 v[158:159], v198 offset:1280
    v_mfma_f32_32x32x16_bf16 v[76:91], v[148:151], v[24:27], v[124:139]
    v_exp_f32 v96, v64
    v_exp_f32 v97, v65
    v_exp_f32 v98, v66
    v_exp_f32 v99, v67
    v_mfma_f32_32x32x16_bf16 v[76:91], v[144:147], v[8:11], v[76:91]
L2_finc:
    s_cbranch_scc1 L2_fs1
    v_exp_f32 v100, v68
    v_exp_f32 v101, v69
    v_exp_f32 v102, v70
    v_exp_f32 v103, v71
    v_exp_f32 v104, v72
    v_exp_f32 v105, v73
    v_exp_f32 v106, v74
    v_exp_f32 v107, v75
L2_fs1:
    s_nop 1
    v_mfma_f32_16x16x4_4b_bf16 v[92:107], v[196:197], v[196:197], v[92:107]
    s_nop 7
    v_exp_f32 v108, v76
    v_exp_f32 v109, v77
    v_exp_f32 v110, v78
    v_exp_f32 v111, v79
    v_exp_f32 v112, v80
    v_exp_f32 v113, v81
    v_exp_f32 v114, v82
    v_exp_f32 v115, v83
    s_cbranch_scc1 L2_fs2
    v_exp_f32 v116, v84
    v_exp_f32 v117, v85
    v_exp_f32 v118, v86
    v_exp_f32 v119, v87
    v_exp_f32 v120, v88
    v_exp_f32 v121, v89
    v_exp_f32 v122, v90
    v_exp_f32 v123, v91
L2_fs2:
    s_waitcnt lgkmcnt(0)
    s_nop 0
    v_mfma_f32_16x16x4_4b_bf16 v[108:123], v[196:197], v[196:197], v[108:123]
    v_rcp_f32 v92, v92
    v_rcp_f32 v93, v93
    v_rcp_f32 v94, v94
    v_rcp_f32 v95, v95
    v_rcp_f32 v96, v96
    v_rcp_f32 v97, v97
    v_rcp_f32 v98, v98
    v_rcp_f32 v99, v99
    s_cbranch_scc1 L2_fs3
    v_rcp_f32 v100, v100
    v_rcp_f32 v101, v101
    v_rcp_f32 v102, v102
    v_rcp_f32 v103, v103
    v_rcp_f32 v104, v104
    v_rcp_f32 v105, v105
    v_rcp_f32 v106, v106
    v_rcp_f32 v107, v107
    s_nop 0
    v_pk_mul_f32 v[68:69], v[68:69], v[100:101]
    v_pk_mul_f32 v[70:71], v[70:71], v[102:103]
    v_pk_mul_f32 v[72:73], v[72:73], v[104:105]
    v_pk_mul_f32 v[74:75], v[74:75], v[106:107]
L2_fs3:
    v_pk_mul_f32 v[60:61], v[60:61], v[92:93]
    v_pk_mul_f32 v[62:63], v[62:63], v[94:95]
    v_pk_mul_f32 v[64:65], v[64:65], v[96:97]
    v_pk_mul_f32 v[66:67], v[66:67], v[98:99]
    s_cbranch_scc1 L2_fs4
    v_smfmac_f32_32x32x32_bf16 v[28:43], v[156:159], v[68:75], v191
L2_fs4:
    s_nop 0
    v_smfmac_f32_32x32x32_bf16 v[28:43], v[152:155], v[60:67], v191
    v_rcp_f32 v108, v108
    v_rcp_f32 v109, v109
    v_rcp_f32 v110, v110
    v_rcp_f32 v111, v111
    v_rcp_f32 v112, v112
    v_rcp_f32 v113, v113
    v_rcp_f32 v114, v114
    v_rcp_f32 v115, v115
    s_cbranch_scc1 L2_fs5
    v_rcp_f32 v116, v116
    v_rcp_f32 v117, v117
    v_rcp_f32 v118, v118
    v_rcp_f32 v119, v119
    v_rcp_f32 v120, v120
    v_rcp_f32 v121, v121
    v_rcp_f32 v122, v122
    v_rcp_f32 v123, v123
    s_nop 0
    v_pk_mul_f32 v[84:85], v[84:85], v[116:117]
    v_pk_mul_f32 v[86:87], v[86:87], v[118:119]
    v_pk_mul_f32 v[88:89], v[88:89], v[120:121]
    v_pk_mul_f32 v[90:91], v[90:91], v[122:123]
L2_fs5:
    v_pk_mul_f32 v[76:77], v[76:77], v[108:109]
    v_pk_mul_f32 v[78:79], v[78:79], v[110:111]
    v_pk_mul_f32 v[80:81], v[80:81], v[112:113]
    v_pk_mul_f32 v[82:83], v[82:83], v[114:115]
    s_cbranch_scc1 L2_fs6
    v_smfmac_f32_32x32x32_bf16 v[44:59], v[156:159], v[84:91], v191
L2_fs6:
    s_nop 0
    v_smfmac_f32_32x32x32_bf16 v[44:59], v[152:155], v[76:83], v191
L2_tiles_done:
    s_cmp_eq_u32 s56, 0
    s_cbranch_scc0 L2_safe_next
L2_epi:
    s_waitcnt vmcnt(0)
    ds_read_b64_tr_b16 v[12:13], v230 offset:0
    ds_read_b64_tr_b16 v[14:15], v230 offset:128
    ds_read_b64_tr_b16 v[16:17], v230 offset:1024
    ds_read_b64_tr_b16 v[18:19], v230 offset:1152
    ds_read_b64_tr_b16 v[20:21], v230 offset:2048
    ds_read_b64_tr_b16 v[22:23], v230 offset:2176
    ds_read_b64_tr_b16 v[24:25], v230 offset:3072
    ds_read_b64_tr_b16 v[26:27], v230 offset:3200
    ds_read_u16_d16_hi v212, v227 offset:128
    v_mul_f32 v194, s13, v194
    v_mul_f32 v195, s13, v195
    v_mul_f32 v29, v194, v29
    v_mul_f32 v30, v194, v30
    v_mul_f32 v31, v194, v31
    v_mul_f32 v33, v194, v33
    v_mul_f32 v34, v194, v34
    v_mul_f32 v35, v194, v35
    v_mul_f32 v37, v194, v37
    v_mul_f32 v38, v194, v38
    v_mul_f32 v39, v194, v39
    v_mul_f32 v41, v194, v41
    v_mul_f32 v42, v194, v42
    v_mul_f32 v43, v194, v43
    v_mul_f32 v215, s13, v28
    v_mul_f32 v216, s13, v44
    v_cvt_pk_bf16_f32 v215, v215, v216
    ds_write_b32 v228, v215 offset:0
    v_mul_f32 v215, s13, v32
    v_mul_f32 v216, s13, v48
    v_cvt_pk_bf16_f32 v215, v215, v216
    ds_write_b32 v228, v215 offset:256
    v_mul_f32 v215, s13, v36
    v_mul_f32 v216, s13, v52
    v_cvt_pk_bf16_f32 v215, v215, v216
    ds_write_b32 v228, v215 offset:512
    v_mul_f32 v215, s13, v40
    v_mul_f32 v216, s13, v56
    v_cvt_pk_bf16_f32 v215, v215, v216
    ds_write_b32 v228, v215 offset:768
    v_fmac_f32 v29, v195, v45
    v_fmac_f32 v30, v195, v46
    v_fmac_f32 v31, v195, v47
    v_fmac_f32 v33, v195, v49
    v_fmac_f32 v34, v195, v50
    v_fmac_f32 v35, v195, v51
    v_fmac_f32 v37, v195, v53
    v_fmac_f32 v38, v195, v54
    v_fmac_f32 v39, v195, v55
    v_fmac_f32 v41, v195, v57
    v_fmac_f32 v42, v195, v58
    v_fmac_f32 v43, v195, v59
    v_permlane16_swap_b32 v29, v33
    v_permlane16_swap_b32 v30, v34
    v_permlane16_swap_b32 v31, v35
    v_permlane16_swap_b32 v37, v41
    v_permlane16_swap_b32 v38, v42
    v_permlane16_swap_b32 v39, v43
    v_add_f32 v29, v29, v33
    v_add_f32 v30, v30, v34
    v_add_f32 v31, v31, v35
    v_add_f32 v37, v37, v41
    v_add_f32 v38, v38, v42
    v_add_f32 v39, v39, v43
    v_add_f32_dpp v188, v29, v29 row_ror:8 row_mask:0xf bank_mask:0xf
    v_add_f32_dpp v189, v30, v30 row_ror:8 row_mask:0xf bank_mask:0xf
    v_add_f32_dpp v190, v31, v31 row_ror:8 row_mask:0xf bank_mask:0xf
    v_add_f32_dpp v188, v37, v37 row_ror:8 row_mask:0xf bank_mask:0xc
    v_add_f32_dpp v189, v38, v38 row_ror:8 row_mask:0xf bank_mask:0xc
    v_add_f32_dpp v190, v39, v39 row_ror:8 row_mask:0xf bank_mask:0xc
    v_add_f32_dpp v188, v188, v188 row_half_mirror row_mask:0xf bank_mask:0xf
    v_add_f32_dpp v189, v189, v189 row_half_mirror row_mask:0xf bank_mask:0xf
    v_add_f32_dpp v190, v190, v190 row_half_mirror row_mask:0xf bank_mask:0xf
    v_add_f32_dpp v188, v188, v188 quad_perm:[1,0,3,2] row_mask:0xf bank_mask:0xf
    v_add_f32_dpp v189, v189, v189 quad_perm:[1,0,3,2] row_mask:0xf bank_mask:0xf
    v_add_f32_dpp v190, v190, v190 quad_perm:[1,0,3,2] row_mask:0xf bank_mask:0xf
    v_add_f32_dpp v188, v188, v188 quad_perm:[2,3,0,1] row_mask:0xf bank_mask:0xf
    v_add_f32_dpp v189, v189, v189 quad_perm:[2,3,0,1] row_mask:0xf bank_mask:0xf
    v_add_f32_dpp v190, v190, v190 quad_perm:[2,3,0,1] row_mask:0xf bank_mask:0xf
    s_mov_b32 exec_lo, 0x01010101
    s_mov_b32 exec_hi, 0x01010101
    ds_write_b96 v229, v[188:190] offset:1024
    s_mov_b64 exec, -1
    s_waitcnt lgkmcnt(0)
    s_barrier
    ds_read_b128 v[92:95], v219 offset:0
    ds_read_b128 v[96:99], v219 offset:64
    ds_read_b128 v[100:103], v220 offset:0
    ds_read_b128 v[104:107], v220 offset:64
    ds_read_b128 v[108:111], v221 offset:0
    ds_read_b128 v[112:115], v221 offset:64
    ds_read_b128 v[116:119], v222 offset:0
    ds_read_b128 v[120:123], v222 offset:64
    ds_read_b32 v225, v225
    ds_read_b32 v226, v226
    v_mfma_f32_16x16x32_bf16 v[60:63], v[12:15], v[164:167], 0
    v_mfma_f32_16x16x32_bf16 v[64:67], v[12:15], v[172:175], 0
    v_mfma_f32_16x16x32_bf16 v[60:63], v[16:19], v[168:171], v[60:63]
    v_mfma_f32_16x16x32_bf16 v[64:67], v[16:19], v[176:179], v[64:67]
    v_lshlrev_b32 v140, 16, v180
    v_and_b32 v141, s14, v180
    v_lshlrev_b32 v142, 16, v181
    v_and_b32 v143, s14, v181
    v_lshlrev_b32 v144, 16, v182
    v_and_b32 v145, s14, v182
    v_lshlrev_b32 v146, 16, v183
    v_and_b32 v147, s14, v183
    v_cmp_gt_u32 vcc, 147, v0
    s_waitcnt lgkmcnt(6)
    v_mfma_f32_16x16x32_bf16 v[60:63], v[20:23], v[92:95], v[60:63]
    v_mfma_f32_16x16x32_bf16 v[60:63], v[24:27], v[96:99], v[60:63]
    v_mfma_f32_16x16x32_bf16 v[60:63], v[20:23], v[100:103], v[60:63]
    v_mfma_f32_16x16x32_bf16 v[60:63], v[24:27], v[104:107], v[60:63]
    s_waitcnt lgkmcnt(2)
    v_mfma_f32_16x16x32_bf16 v[64:67], v[20:23], v[108:111], v[64:67]
    v_mfma_f32_16x16x32_bf16 v[64:67], v[24:27], v[112:115], v[64:67]
    v_mfma_f32_16x16x32_bf16 v[64:67], v[20:23], v[116:119], v[64:67]
    v_mfma_f32_16x16x32_bf16 v[64:67], v[24:27], v[120:123], v[64:67]
    s_waitcnt lgkmcnt(0)
    v_add_f32 v225, v225, v226
    v_cvt_pk_bf16_f32 v225, 0, v225
    v_add_f32 v225, v225, v212
    v_cvt_pk_bf16_f32 v225, v225, v225
    s_mov_b64 exec, vcc
    buffer_store_short v225, v227, s[44:47], 0 offen
    s_mov_b64 exec, -1
    v_cvt_pk_bf16_f32 v60, 0, v60
    v_cvt_pk_bf16_f32 v61, 0, v61
    v_cvt_pk_bf16_f32 v62, 0, v62
    v_cvt_pk_bf16_f32 v63, 0, v63
    v_cvt_pk_bf16_f32 v64, 0, v64
    v_cvt_pk_bf16_f32 v65, 0, v65
    v_cvt_pk_bf16_f32 v66, 0, v66
    v_cvt_pk_bf16_f32 v67, 0, v67
    v_pk_mul_f32 v[124:125], v[60:61], s[12:13] op_sel_hi:[1,0]
    v_pk_mul_f32 v[126:127], v[62:63], s[12:13] op_sel_hi:[1,0]
    v_pk_mul_f32 v[128:129], v[64:65], s[12:13] op_sel_hi:[1,0]
    v_pk_mul_f32 v[130:131], v[66:67], s[12:13] op_sel_hi:[1,0]
    v_exp_f32 v124, v124
    v_exp_f32 v125, v125
    v_exp_f32 v126, v126
    v_exp_f32 v127, v127
    v_exp_f32 v128, v128
    v_exp_f32 v129, v129
    v_exp_f32 v130, v130
    v_exp_f32 v131, v131
    v_pk_add_f32 v[124:125], v[124:125], 1.0 op_sel_hi:[1,0]
    v_pk_add_f32 v[126:127], v[126:127], 1.0 op_sel_hi:[1,0]
    v_pk_add_f32 v[128:129], v[128:129], 1.0 op_sel_hi:[1,0]
    v_pk_add_f32 v[130:131], v[130:131], 1.0 op_sel_hi:[1,0]
    v_rcp_f32 v124, v124
    v_rcp_f32 v125, v125
    v_rcp_f32 v126, v126
    v_rcp_f32 v127, v127
    v_rcp_f32 v128, v128
    v_rcp_f32 v129, v129
    v_rcp_f32 v130, v130
    v_rcp_f32 v131, v131
    v_pk_mul_f32 v[60:61], v[60:61], v[124:125]
    v_pk_mul_f32 v[62:63], v[62:63], v[126:127]
    v_pk_mul_f32 v[64:65], v[64:65], v[128:129]
    v_pk_mul_f32 v[66:67], v[66:67], v[130:131]
    v_cvt_pk_bf16_f32 v60, 0, v60
    v_cvt_pk_bf16_f32 v61, 0, v61
    v_cvt_pk_bf16_f32 v62, 0, v62
    v_cvt_pk_bf16_f32 v63, 0, v63
    v_pk_add_f32 v[60:61], v[60:61], v[140:141]
    v_pk_add_f32 v[62:63], v[62:63], v[142:143]
    v_cvt_pk_bf16_f32 v180, v60, v61
    v_cvt_pk_bf16_f32 v181, v62, v63
    buffer_store_dwordx2 v[180:181], v233, s[40:43], 0 offen
    v_cvt_pk_bf16_f32 v64, 0, v64
    v_cvt_pk_bf16_f32 v65, 0, v65
    v_cvt_pk_bf16_f32 v66, 0, v66
    v_cvt_pk_bf16_f32 v67, 0, v67
    v_pk_add_f32 v[64:65], v[64:65], v[144:145]
    v_pk_add_f32 v[66:67], v[66:67], v[146:147]
    v_cvt_pk_bf16_f32 v182, v64, v65
    v_cvt_pk_bf16_f32 v183, v66, v67
    buffer_store_dwordx2 v[182:183], v224, s[40:43], 0 offen
L2_end:
    s_endpgm
L2_tailp:
    s_mov_b32 s93, 2
    s_waitcnt vmcnt(0)
    s_branch L2_fp
L2_tail0:
    s_mov_b32 s93, 0
    s_waitcnt vmcnt(0)
    s_branch L2_fp
L2_tail1:
    s_mov_b32 s93, 1
    s_waitcnt vmcnt(0)
    s_branch L2_fp
L2_notiles:
    s_mov_b32 s93, 3
L2_fp:
    buffer_load_dwordx4 v231, s[36:39], 0 offen lds
    buffer_load_dwordx4 v231, s[36:39], s6 offen offset:1024 lds
    buffer_load_dwordx4 v232, s[36:39], 0 offen offset:2048 lds
    buffer_load_dwordx4 v232, s[36:39], s4 offen offset:3072 lds
    buffer_load_short_d16_hi v194, v234, s[32:35], 0 offen
    buffer_load_short_d16_hi v195, v234, s[32:35], 0 offen offset:64
    s_cmp_eq_u32 s93, 0
    s_cbranch_scc1 L2_cont0
    s_cmp_eq_u32 s93, 1
    s_cbranch_scc1 L2_cont1
    s_cmp_eq_u32 s93, 2
    s_cbranch_scc1 L2_contp
    s_branch L2_tiles_done
L2_more:
    v_subrev_u32 v241, 128, v241
    v_add_u32 v84, 128, v84
    v_subrev_u32 v242, 128, v242
    v_add_u32 v85, 128, v85
    v_subrev_u32 v243, 128, v243
    v_add_u32 v86, 128, v86
    v_subrev_u32 v244, 128, v244
    v_add_u32 v87, 128, v87
    v_subrev_u32 v245, 128, v245
    v_add_u32 v88, 128, v88
    v_subrev_u32 v246, 128, v246
    v_add_u32 v89, 128, v89
    v_subrev_u32 v247, 128, v247
    v_add_u32 v90, 128, v90
    v_subrev_u32 v248, 128, v248
    v_add_u32 v91, 128, v91
    v_cmp_lt_i32 s[58:59], 64, v241
    v_cmp_lt_i32 s[56:57], 0, v241
    v_cmp_lt_i32 s[62:63], 64, v242
    v_cmp_lt_i32 s[60:61], 0, v242
    v_cmp_lt_i32 s[66:67], 64, v243
    v_cmp_lt_i32 s[64:65], 0, v243
    v_cmp_lt_i32 s[70:71], 64, v244
    v_cmp_lt_i32 s[68:69], 0, v244
    v_cmp_lt_i32 s[74:75], 64, v245
    v_cmp_lt_i32 s[72:73], 0, v245
    v_cmp_lt_i32 s[78:79], 64, v246
    v_cmp_lt_i32 s[76:77], 0, v246
    v_cmp_lt_i32 s[82:83], 64, v247
    v_cmp_lt_i32 s[80:81], 0, v247
    v_cmp_lt_i32 s[86:87], 64, v248
    v_cmp_lt_i32 s[84:85], 0, v248
    s_mov_b64 exec, s[56:57]
    buffer_load_dword v124, v84, s[48:51], 0 offen sc1
    s_mov_b64 exec, s[58:59]
    s_cbranch_execz L2_rsb0
    buffer_load_dword v125, v84, s[48:51], 0 offen offset:64 sc1
L2_rsb0:
    s_mov_b64 exec, s[60:61]
    buffer_load_dword v126, v85, s[48:51], 0 offen sc1
    s_mov_b64 exec, s[62:63]
    s_cbranch_execz L2_rsb1
    buffer_load_dword v127, v85, s[48:51], 0 offen offset:64 sc1
L2_rsb1:
    s_mov_b64 exec, s[64:65]
    buffer_load_dword v128, v86, s[48:51], 0 offen sc1
    s_mov_b64 exec, s[66:67]
    s_cbranch_execz L2_rsb2
    buffer_load_dword v129, v86, s[48:51], 0 offen offset:64 sc1
L2_rsb2:
    s_mov_b64 exec, s[68:69]
    buffer_load_dword v130, v87, s[48:51], 0 offen sc1
    s_mov_b64 exec, s[70:71]
    s_cbranch_execz L2_rsb3
    buffer_load_dword v131, v87, s[48:51], 0 offen offset:64 sc1
L2_rsb3:
    s_mov_b64 exec, s[72:73]
    buffer_load_dword v132, v88, s[48:51], 0 offen sc1
    s_mov_b64 exec, s[74:75]
    s_cbranch_execz L2_rsb4
    buffer_load_dword v133, v88, s[48:51], 0 offen offset:64 sc1
L2_rsb4:
    s_mov_b64 exec, s[76:77]
    buffer_load_dword v134, v89, s[48:51], 0 offen sc1
    s_mov_b64 exec, s[78:79]
    s_cbranch_execz L2_rsb5
    buffer_load_dword v135, v89, s[48:51], 0 offen offset:64 sc1
L2_rsb5:
    s_mov_b64 exec, s[80:81]
    buffer_load_dword v136, v90, s[48:51], 0 offen sc1
    s_mov_b64 exec, s[82:83]
    s_cbranch_execz L2_rsb6
    buffer_load_dword v137, v90, s[48:51], 0 offen offset:64 sc1
L2_rsb6:
    s_mov_b64 exec, s[84:85]
    buffer_load_dword v138, v91, s[48:51], 0 offen sc1
    s_mov_b64 exec, s[86:87]
    s_cbranch_execz L2_rsb7
    buffer_load_dword v139, v91, s[48:51], 0 offen offset:64 sc1
L2_rsb7:
    s_mov_b64 exec, -1
    v_subrev_u32 v155, 128, v155
    s_mul_i32 s91, s88, 12544
    s_waitcnt vmcnt(0)
    s_mov_b64 exec, s[56:57]
    v_and_b32 v108, 56, v124
    ds_add_rtn_u32 v108, v108, v156 offset:0
    v_lshrrev_b32 v92, 20, v124
    v_lshlrev_b32 v124, 1, v124
    v_add3_u32 v92, v92, v154, s91
    s_mov_b64 exec, s[58:59]
    s_cbranch_execz L2_iab1
    v_and_b32 v109, 56, v125
    ds_add_rtn_u32 v109, v109, v156 offset:0
    v_lshrrev_b32 v93, 20, v125
    v_lshlrev_b32 v125, 1, v125
    v_add3_u32 v93, v93, v154, s91
L2_iab1:
    s_add_u32 s91, s91, 100352
    s_mov_b64 exec, s[60:61]
    v_and_b32 v110, 56, v126
    ds_add_rtn_u32 v110, v110, v156 offset:0
    v_lshrrev_b32 v94, 20, v126
    v_lshlrev_b32 v126, 1, v126
    v_add3_u32 v94, v94, v154, s91
    s_mov_b64 exec, s[62:63]
    s_cbranch_execz L2_iab3
    v_and_b32 v111, 56, v127
    ds_add_rtn_u32 v111, v111, v156 offset:0
    v_lshrrev_b32 v95, 20, v127
    v_lshlrev_b32 v127, 1, v127
    v_add3_u32 v95, v95, v154, s91
L2_iab3:
    s_add_u32 s91, s91, 100352
    s_waitcnt lgkmcnt(1)
    s_mov_b64 exec, s[56:57]
    v_min_u32 v108, 143484, v108
    ds_write2st64_b32 v108, v124, v92 offset1:64
    s_mov_b64 exec, s[58:59]
    s_cbranch_execz L2_ibb1
    v_min_u32 v109, 143484, v109
    ds_write2st64_b32 v109, v125, v93 offset1:64
L2_ibb1:
    s_mov_b64 exec, s[64:65]
    v_and_b32 v112, 56, v128
    ds_add_rtn_u32 v112, v112, v156 offset:0
    v_lshrrev_b32 v96, 20, v128
    v_lshlrev_b32 v128, 1, v128
    v_add3_u32 v96, v96, v154, s91
    s_mov_b64 exec, s[66:67]
    s_cbranch_execz L2_iab5
    v_and_b32 v113, 56, v129
    ds_add_rtn_u32 v113, v113, v156 offset:0
    v_lshrrev_b32 v97, 20, v129
    v_lshlrev_b32 v129, 1, v129
    v_add3_u32 v97, v97, v154, s91
L2_iab5:
    s_add_u32 s91, s91, 100352
    s_waitcnt lgkmcnt(2)
    s_mov_b64 exec, s[60:61]
    v_min_u32 v110, 143484, v110
    ds_write2st64_b32 v110, v126, v94 offset1:64
    s_mov_b64 exec, s[62:63]
    s_cbranch_execz L2_ibb3
    v_min_u32 v111, 143484, v111
    ds_write2st64_b32 v111, v127, v95 offset1:64
L2_ibb3:
    s_mov_b64 exec, s[68:69]
    v_and_b32 v114, 56, v130
    ds_add_rtn_u32 v114, v114, v156 offset:0
    v_lshrrev_b32 v98, 20, v130
    v_lshlrev_b32 v130, 1, v130
    v_add3_u32 v98, v98, v154, s91
    s_mov_b64 exec, s[70:71]
    s_cbranch_execz L2_iab7
    v_and_b32 v115, 56, v131
    ds_add_rtn_u32 v115, v115, v156 offset:0
    v_lshrrev_b32 v99, 20, v131
    v_lshlrev_b32 v131, 1, v131
    v_add3_u32 v99, v99, v154, s91
L2_iab7:
    s_add_u32 s91, s91, 100352
    s_waitcnt lgkmcnt(2)
    s_mov_b64 exec, s[64:65]
    v_min_u32 v112, 143484, v112
    ds_write2st64_b32 v112, v128, v96 offset1:64
    s_mov_b64 exec, s[66:67]
    s_cbranch_execz L2_ibb5
    v_min_u32 v113, 143484, v113
    ds_write2st64_b32 v113, v129, v97 offset1:64
L2_ibb5:
    s_mov_b64 exec, s[72:73]
    v_and_b32 v116, 56, v132
    ds_add_rtn_u32 v116, v116, v156 offset:0
    v_lshrrev_b32 v100, 20, v132
    v_lshlrev_b32 v132, 1, v132
    v_add3_u32 v100, v100, v154, s91
    s_mov_b64 exec, s[74:75]
    s_cbranch_execz L2_iab9
    v_and_b32 v117, 56, v133
    ds_add_rtn_u32 v117, v117, v156 offset:0
    v_lshrrev_b32 v101, 20, v133
    v_lshlrev_b32 v133, 1, v133
    v_add3_u32 v101, v101, v154, s91
L2_iab9:
    s_add_u32 s91, s91, 100352
    s_waitcnt lgkmcnt(2)
    s_mov_b64 exec, s[68:69]
    v_min_u32 v114, 143484, v114
    ds_write2st64_b32 v114, v130, v98 offset1:64
    s_mov_b64 exec, s[70:71]
    s_cbranch_execz L2_ibb7
    v_min_u32 v115, 143484, v115
    ds_write2st64_b32 v115, v131, v99 offset1:64
L2_ibb7:
    s_mov_b64 exec, s[76:77]
    v_and_b32 v118, 56, v134
    ds_add_rtn_u32 v118, v118, v156 offset:0
    v_lshrrev_b32 v102, 20, v134
    v_lshlrev_b32 v134, 1, v134
    v_add3_u32 v102, v102, v154, s91
    s_mov_b64 exec, s[78:79]
    s_cbranch_execz L2_iab11
    v_and_b32 v119, 56, v135
    ds_add_rtn_u32 v119, v119, v156 offset:0
    v_lshrrev_b32 v103, 20, v135
    v_lshlrev_b32 v135, 1, v135
    v_add3_u32 v103, v103, v154, s91
L2_iab11:
    s_add_u32 s91, s91, 100352
    s_waitcnt lgkmcnt(2)
    s_mov_b64 exec, s[72:73]
    v_min_u32 v116, 143484, v116
    ds_write2st64_b32 v116, v132, v100 offset1:64
    s_mov_b64 exec, s[74:75]
    s_cbranch_execz L2_ibb9
    v_min_u32 v117, 143484, v117
    ds_write2st64_b32 v117, v133, v101 offset1:64
L2_ibb9:
    s_mov_b64 exec, s[80:81]
    v_and_b32 v120, 56, v136
    ds_add_rtn_u32 v120, v120, v156 offset:0
    v_lshrrev_b32 v104, 20, v136
    v_lshlrev_b32 v136, 1, v136
    v_add3_u32 v104, v104, v154, s91
    s_mov_b64 exec, s[82:83]
    s_cbranch_execz L2_iab13
    v_and_b32 v121, 56, v137
    ds_add_rtn_u32 v121, v121, v156 offset:0
    v_lshrrev_b32 v105, 20, v137
    v_lshlrev_b32 v137, 1, v137
    v_add3_u32 v105, v105, v154, s91
L2_iab13:
    s_add_u32 s91, s91, 100352
    s_waitcnt lgkmcnt(2)
    s_mov_b64 exec, s[76:77]
    v_min_u32 v118, 143484, v118
    ds_write2st64_b32 v118, v134, v102 offset1:64
    s_mov_b64 exec, s[78:79]
    s_cbranch_execz L2_ibb11
    v_min_u32 v119, 143484, v119
    ds_write2st64_b32 v119, v135, v103 offset1:64
L2_ibb11:
    s_mov_b64 exec, s[84:85]
    v_and_b32 v122, 56, v138
    ds_add_rtn_u32 v122, v122, v156 offset:0
    v_lshrrev_b32 v106, 20, v138
    v_lshlrev_b32 v138, 1, v138
    v_add3_u32 v106, v106, v154, s91
    s_mov_b64 exec, s[86:87]
    s_cbranch_execz L2_iab15
    v_and_b32 v123, 56, v139
    ds_add_rtn_u32 v123, v123, v156 offset:0
    v_lshrrev_b32 v107, 20, v139
    v_lshlrev_b32 v139, 1, v139
    v_add3_u32 v107, v107, v154, s91
L2_iab15:
    s_waitcnt lgkmcnt(2)
    s_mov_b64 exec, s[80:81]
    v_min_u32 v120, 143484, v120
    ds_write2st64_b32 v120, v136, v104 offset1:64
    s_mov_b64 exec, s[82:83]
    s_cbranch_execz L2_ibb13
    v_min_u32 v121, 143484, v121
    ds_write2st64_b32 v121, v137, v105 offset1:64
L2_ibb13:
    s_waitcnt lgkmcnt(1)
    s_mov_b64 exec, s[84:85]
    v_min_u32 v122, 143484, v122
    ds_write2st64_b32 v122, v138, v106 offset1:64
    s_mov_b64 exec, s[86:87]
    s_cbranch_execz L2_ibb15
    v_min_u32 v123, 143484, v123
    ds_write2st64_b32 v123, v139, v107 offset1:64
L2_ibb15:
    s_mov_b64 exec, -1
    v_cmp_lt_i32 vcc, 0, v155
    s_cbranch_vccnz L2_more
    s_branch L2_insdone
L_code_end:
L2_overflow:
    v_readlane_b32 s91, v215, 0
    s_bitcmp1_b32 s91, 28
    s_cbranch_scc1 L2_solo
    s_mov_b32 s56, 1
    s_mov_b32 s57, 0
    s_mov_b32 s58, 0
L2_safe_next:
    s_cmp_eq_u32 s56, 2
    s_cbranch_scc1 L2_solo_next
    s_lshl_b32 s91, s57, 8
    s_add_u32 s91, s91, s89
    s_lshl_b32 s91, s91, 2
    buffer_load_dword v215, v184, s[52:55], s91 offen sc1
    s_waitcnt vmcnt(0)
    v_readfirstlane_b32 s93, v215
    s_bitset0_b32 s93, 31
    s_lshr_b32 s94, s93, 16
    s_cmp_lt_u32 s58, s94
    s_cbranch_scc1 L2_safe_go
    s_mov_b32 s58, 0
    s_add_u32 s57, s57, 1
    s_cmp_lt_u32 s57, 256
    s_cbranch_scc1 L2_safe_next
    s_branch L2_epi
L2_safe_go:
    s_waitcnt vmcnt(0) lgkmcnt(0)
    s_barrier
    v_subrev_u32 v218, 2048, v238
    ds_write_b32 v237, v218 offset:0
    s_lshl_b32 s92, s88, 11
    s_add_u32 s92, s92, 127104
    v_and_or_b32 v202, v1, 56, s92
    v_bfe_u32 v203, v1, 3, 1
    v_lshl_add_u32 v203, v203, 2, v237
    v_and_b32 v204, 16, v1
    v_lshl_add_u32 v203, v204, 2, v203
    v_add_u32 v203, s92, v203
    v_lshl_add_u32 v204, v3, 3, v203
    v_lshl_add_u32 v200, v3, 1, v199
    ds_write_b128 v200, v[184:187]
    ds_write_b128 v200, v[184:187] offset:16
    ds_write2st64_b32 v203, v191, v191 offset1:64
    v_mov_b32 v192, 0x186a0e
    v_bfrev_b32 v193, 1
    s_mov_b32 s7, 0
    s_mul_i32 s91, s57, 12544
    s_and_b32 s93, s93, 0xffff
    s_add_u32 s93, s93, s91
    s_lshr_b32 s91, s91, 2
    v_lshl_add_u32 v217, v0, 2, s58
    s_add_u32 s58, s58, 2048
    buffer_load_dword v215, v217, s[48:51], s93 offen sc1
    v_cmp_gt_u32 vcc, s94, v217
    v_mov_b32 v218, 4
    s_waitcnt vmcnt(0) lgkmcnt(0)
    s_barrier
    s_mov_b64 exec, vcc
    v_and_b32 v217, 56, v215
    ds_add_rtn_u32 v217, v217, v218 offset:0
    v_lshrrev_b32 v216, 20, v215
    v_lshlrev_b32 v215, 1, v215
    v_add_u32 v216, s91, v216
    s_waitcnt lgkmcnt(0)
    ds_write2st64_b32 v217, v215, v216 offset1:64
    s_mov_b64 exec, -1
    s_branch L2_after_insert
L2_solo:
    s_load_dwordx2 s[60:61], s[0:1], 0
    s_load_dwordx2 s[64:65], s[0:1], 40
    s_mov_b32 s56, 2
    s_waitcnt vmcnt(0) lgkmcnt(0)
    s_barrier
    s_mov_b32 s62, 0x186a00
    s_mov_b32 s63, 0x20000
    s_mov_b32 s66, 0x4880
    s_mov_b32 s67, 0x20000
    v_lshrrev_b32 v3, 5, v1
    v_lshlrev_b32 v3, 4, v3
    v_lshrrev_b32 v215, 4, v1
    v_bfe_u32 v218, v1, 2, 2
    s_and_b32 s91, s88, 3
    s_lshl_b32 s91, s91, 5
    s_lshr_b32 s92, s88, 2
    s_lshl_b32 s92, s92, 5
    v_lshl_add_u32 v216, v215, 3, v218
    v_and_b32 v217, 3, v1
    v_lshlrev_b32 v217, 3, v217
    v_lshl_add_u32 v230, v216, 5, v217
    v_add_u32 v230, s95, v230
    v_lshl_add_u32 v145, v216, 7, v217
    v_add_u32 v145, 84096, v145
    v_add_u32 v145, s91, v145
    v_and_or_b32 v223, v1, 15, s92
    v_lshlrev_b32 v216, 7, v223
    v_lshl_add_u32 v217, v215, 3, s91
    v_add_u32 v148, v216, v217
    s_lshl_b32 s92, s90, 7
    v_add_u32 v233, s92, v148
    v_lshl_add_u32 v148, v223, 4, v148
    v_add_u32 v148, 127104, v148
    v_bfe_u32 v218, v1, 1, 3
    v_lshlrev_b32 v218, 4, v218
    v_add_u32 v216, 96384, v216
    v_xad_u32 v147, v217, v218, v216
    v_lshlrev_b32 v215, 4, v215
    v_xad_u32 v146, v215, v218, v216
    s_mov_b32 s81, 684785
    s_mov_b32 s82, -65
    v_lshlrev_b32 v160, 4, v1
    s_and_b32 s91, s88, 1
    s_lshl_b32 s91, s91, 2
    v_lshrrev_b32 v216, 4, v1
    v_add_u32 v216, s91, v216
    v_xor_b32 v216, v216, v1
    v_lshlrev_b32 v161, 4, v216
    v_lshlrev_b32 v163, 4, v0
    v_lshrrev_b32 v216, 3, v0
    v_lshl_add_u32 v216, v216, 4, v163
    v_add_u32 v162, 127104, v216
    v_xor_b32 v217, 64, v146
    v_cmp_gt_u32 vcc, 392, v0
    s_lshl_b32 s58, s88, 10
    s_add_u32 m0, s58, 84096
    s_add_u32 s92, s58, 8192
    buffer_load_dwordx4 v160, s[64:67], s92 offen lds
    s_add_u32 m0, s58, 96384
    s_mov_b32 s57, 0
L2_solo_b:
    buffer_load_dwordx4 v161, s[60:63], s58 offen lds
    s_waitcnt vmcnt(0)
    s_barrier
    ds_read_b64_tr_b16 v[92:93], v145 offset:0
    ds_read_b64_tr_b16 v[94:95], v145 offset:512
    ds_read_b64_tr_b16 v[96:97], v145 offset:4096
    ds_read_b64_tr_b16 v[98:99], v145 offset:4608
    ds_read_b128 v[124:127], v146 offset:0
    ds_read_b128 v[128:131], v217 offset:0
    ds_read_b128 v[132:135], v146 offset:2048
    ds_read_b128 v[136:139], v217 offset:2048
    s_waitcnt lgkmcnt(0)
    v_mfma_f32_16x16x32_bf16 v[100:103], v[92:95], v[124:127], 0
    v_mfma_f32_16x16x32_bf16 v[104:107], v[92:95], v[132:135], 0
    v_mfma_f32_16x16x32_bf16 v[100:103], v[96:99], v[128:131], v[100:103]
    v_mfma_f32_16x16x32_bf16 v[104:107], v[96:99], v[136:139], v[104:107]
    s_nop 6
    v_mul_f32 v100, s12, v100
    v_mul_f32 v101, s12, v101
    v_mul_f32 v102, s12, v102
    v_mul_f32 v103, s12, v103
    v_cvt_pk_bf16_f32 v100, v100, v101
    v_cvt_pk_bf16_f32 v101, v102, v103
    ds_write_b64 v148, v[100:101] offset:0
    v_mul_f32 v104, s12, v104
    v_mul_f32 v105, s12, v105
    v_mul_f32 v106, s12, v106
    v_mul_f32 v107, s12, v107
    v_cvt_pk_bf16_f32 v104, v104, v105
    v_cvt_pk_bf16_f32 v105, v106, v107
    ds_write_b64 v148, v[104:105] offset:2304
    s_waitcnt lgkmcnt(0)
    s_barrier
    ds_read_b128 v[108:111], v162
    s_mov_b64 exec, vcc
    s_waitcnt lgkmcnt(0)
    buffer_store_dwordx4 v[108:111], v163, s[28:31], 0 offen offset:3072 sc1
    s_mov_b64 exec, -1
    v_add_u32 v163, 6272, v163
    s_add_u32 s58, s58, 6272
    s_add_u32 s57, s57, 1
    s_cmp_lt_u32 s57, 256
    s_cbranch_scc1 L2_solo_b
    s_waitcnt vmcnt(0)
    s_barrier
    buffer_inv sc1
    s_mov_b32 s58, 0
L2_solo_next:
    s_cmp_ge_u32 s58, 3200000
    s_cbranch_scc1 L2_epi
    s_load_dwordx2 s[68:69], s[0:1], 24
    s_load_dwordx2 s[72:73], s[0:1], 32
    s_waitcnt vmcnt(0) lgkmcnt(0)
    s_barrier
    s_mov_b32 s70, 0x30d400
    s_mov_b32 s71, 0x20000
    s_mov_b32 s74, 0x30d400
    s_mov_b32 s75, 0x20000
    v_subrev_u32 v218, 2048, v238
    ds_write_b32 v237, v218 offset:0
    s_lshl_b32 s92, s88, 11
    s_add_u32 s92, s92, 127104
    v_and_or_b32 v202, v1, 56, s92
    v_bfe_u32 v203, v1, 3, 1
    v_lshl_add_u32 v203, v203, 2, v237
    v_and_b32 v204, 16, v1
    v_lshl_add_u32 v203, v204, 2, v203
    v_add_u32 v203, s92, v203
    v_lshl_add_u32 v204, v3, 3, v203
    v_lshl_add_u32 v200, v3, 1, v199
    ds_write_b128 v200, v[184:187]
    ds_write_b128 v200, v[184:187] offset:16
    ds_write2st64_b32 v203, v191, v191 offset1:64
    v_mov_b32 v192, 0x186a0e
    v_bfrev_b32 v193, 1
    s_mov_b32 s7, 0
    v_lshl_add_u32 v217, v0, 2, s58
    s_add_u32 s58, s58, 2048
    buffer_load_dword v215, v217, s[72:75], 0 offen
    buffer_load_dword v216, v217, s[68:71], 0 offen
    v_cmp_gt_u32 vcc, 3200000, v217
    v_lshrrev_b32 v217, 2, v217
    s_waitcnt vmcnt(0) lgkmcnt(0)
    s_barrier
    s_mov_b64 exec, vcc
    v_lshlrev_b32 v218, 10, v215
    v_mul_hi_u32_u24 v218, s81, v218
    v_lshl_add_u32 v215, v218, 1, v215
    v_lshrrev_b32 v218, 3, v218
    v_cmp_eq_u32 vcc, s89, v218
    v_mad_i32_i24 v215, v218, s82, v215
    s_mov_b64 exec, vcc
    v_lshl_add_u32 v216, v216, 6, v215
    v_and_b32 v215, 56, v215
    v_mov_b32 v218, 4
    ds_add_rtn_u32 v215, v215, v218 offset:0
    v_lshlrev_b32 v216, 1, v216
    s_waitcnt lgkmcnt(0)
    ds_write2st64_b32 v215, v216, v217 offset1:64
    s_mov_b64 exec, -1
    s_branch L2_after_insert
.section .rodata,"a"
.p2align 6
.amdhsa_kernel standalone__cheap_equivariant_egnn__graph_kernel
.amdhsa_next_free_vgpr 256
.amdhsa_next_free_sgpr 102
.amdhsa_accum_offset 256
.amdhsa_group_segment_fixed_size 0
.amdhsa_kernarg_size 88
.amdhsa_user_sgpr_count 2
.amdhsa_user_sgpr_kernarg_segment_ptr 1
.amdhsa_system_sgpr_workgroup_id_x 1
.amdhsa_float_denorm_mode_32 3
.end_amdhsa_kernel
.text
```
